```python
import torch

def _softmax(x, axis=-1):
    return torch.softmax(x, dim=axis)
def _gelu(x):
    return torch.nn.functional.gelu(x, approximate="tanh")
def _silu(x):
    return torch.nn.functional.silu(x)
def _sigmoid(x):
    return torch.sigmoid(x)
def _layernorm(x, axis=-1, eps=1e-5):
    m = x.mean(dim=axis, keepdim=True)
    v = x.var(dim=axis, keepdim=True, unbiased=False)
    return (x - m) / torch.sqrt(v + eps)
def _scatter_add(tgt, idx, src, axis=0):
    return tgt.clone().index_add_(axis, idx, src)
def _segment_sum(src, seg, n):
    out = torch.zeros((n,) + src.shape[1:], dtype=src.dtype)
    return out.index_add_(0, seg, src)
def _pad(x, pw):
    flat = tuple(v for pair in reversed(pw) for v in pair)
    return torch.nn.functional.pad(x, flat)

kernel_name = 'recurrent_scan__gqa_block_cached__glu_gated_glu__decode'

def setup_inputs():

    _w = (lambda a: (lambda t: t.to(torch.bfloat16) if t.is_floating_point() else t)(torch.as_tensor(a)))
    def _A_setup():
        B, Sq, D = 8, 1, 512
        Hq, Hkv, Sk, Dh = 32, 8, 4096, 128
        assert Hq % Hkv == 0, (Hq, Hkv)
        return {
            "x": _w((lambda *s: torch.randn(*s, dtype=torch.bfloat16) * 0.05)(B, Sq, D)),
            "k_cache": _w((lambda *s: torch.randn(*s, dtype=torch.bfloat16) * 1.6)(B, Hkv, Sk, Dh)),
            "v_cache": _w((lambda *s: torch.randn(*s, dtype=torch.bfloat16) * 0.2)(B, Hkv, Sk, Dh)),
            "wq": _w((lambda *s: torch.randn(*s, dtype=torch.bfloat16) * 1.6)(D, Hq * Dh) * (D ** -0.5)),
            "wo": _w((lambda *s: torch.randn(*s, dtype=torch.bfloat16) * 0.2)(Hq * Dh, D) * ((Hq * Dh) ** -0.5)),
        }
    _A_in = _A_setup()

    def _B_setup():
        B, S, D, F = 8, 1, 512, 1792
        return {
            "x": _w((lambda *s: torch.randn(*s, dtype=torch.bfloat16) * 0.05)(B, S, D)),
            "w_gate": _w((lambda *s: torch.randn(*s, dtype=torch.bfloat16) * 1.6)(D, F)),
            "w_up": _w((lambda *s: torch.randn(*s, dtype=torch.bfloat16) * 0.1)(D, F)),
            "w_down": _w((lambda *s: torch.randn(*s, dtype=torch.bfloat16) * 0.1)(F, D)),
        }
    _B_in = _B_setup()

    return {
        "A_x": _A_in["x"],
        "A_k_cache": _A_in["k_cache"],
        "A_v_cache": _A_in["v_cache"],
        "A_wq": _A_in["wq"],
        "A_wo": _A_in["wo"],
        "B_x": _B_in["x"],
        "B_w_gate": _B_in["w_gate"],
        "B_w_up": _B_in["w_up"],
        "B_w_down": _B_in["w_down"],
    }

def reference(A_x, A_k_cache, A_v_cache, A_wq, A_wo, B_x, B_w_gate, B_w_up, B_w_down):
    def _A_ref(x, k_cache, v_cache, wq, wo):
        B, Sq, D = x.shape
        Hq, Dh = 32, 128
        Hkv = k_cache.shape[1]
        rep = Hq // Hkv
        q = (lambda x, *d: x.permute(*d))((x @ wq).reshape(B, Sq, Hq, Dh), 0, 2, 1, 3)
        k = (lambda x, n, axis: torch.repeat_interleave(x, n, dim=axis))(k_cache, rep, axis=1)
        v = (lambda x, n, axis: torch.repeat_interleave(x, n, dim=axis))(v_cache, rep, axis=1)
        scores = torch.einsum("bhqd,bhkd->bhqk", q, k) * (Dh ** -0.5)
        p = _softmax(scores, axis=-1)
        o = torch.einsum("bhqk,bhkd->bhqd", p, v)
        return (lambda x, *d: x.permute(*d))(o, 0, 2, 1, 3).reshape(B, Sq, Hq * Dh) @ wo

    def _B_ref(x, w_gate, w_up, w_down):
        g = torch.einsum("bsd,df->bsf", x, w_gate)
        u = torch.einsum("bsd,df->bsf", x, w_up)
        h = _sigmoid(g) * u
        return torch.einsum("bsf,fd->bsd", h, w_down)

    x = A_x
    xn = _layernorm(x, axis=-1)
    s = _A_ref(xn, A_k_cache, A_v_cache, A_wq, A_wo)
    g = _silu(_B_ref(xn, B_w_gate, B_w_up, B_w_down))
    return x + s * g
```

```asm
; @launch grid=(256,1,1) block=(512,1,1) lds=70400
.amdgcn_target "amdgcn-amd-amdhsa--gfx950"
.text
.globl recurrent_scan__gqa_block_cached__glu_gated_glu__decode_kernel
.p2align 8
.type recurrent_scan__gqa_block_cached__glu_gated_glu__decode_kernel,@function
recurrent_scan__gqa_block_cached__glu_gated_glu__decode_kernel:
    s_cmp_ge_u32 s2, 256
    s_cbranch_scc1 L_end
    s_load_dwordx16 s[64:79], s[0:1], 0
    s_load_dwordx8 s[80:87], s[0:1], 64
    v_lshrrev_b32 v12, 6, v0
    v_and_b32 v0, 63, v0
    v_readfirstlane_b32 s3, v12
    s_and_b32 s44, s2, 7
    s_lshr_b32 s45, s2, 3
    s_lshl_b32 s46, s44, 5
    s_add_u32 s46, s46, s45
    v_lshlrev_b32 v3, 4, v0
    v_bfe_u32 v12, v0, 2, 2
    v_lshlrev_b32 v1, 8, v12
    v_lshrrev_b32 v12, 4, v0
    v_lshl_add_u32 v1, v12, 6, v1
    v_and_b32 v12, 3, v0
    v_lshl_add_u32 v1, v12, 4, v1
    s_lshl_b32 s55, s3, 13
    v_add_u32 v1, s55, v1
    v_add_u32 v2, s55, v3
    v_lshrrev_b32 v13, 3, v0
    v_mul_u32_u24 v13, 8192, v13
    v_and_b32 v15, 7, v0
    v_lshl_add_u32 v13, v15, 4, v13
    v_lshrrev_b32 v14, 3, v0
    v_mul_u32_u24 v14, 3584, v14
    v_and_b32 v15, 7, v0
    v_lshl_add_u32 v14, v15, 4, v14
    s_and_b32 s31, s45, 3
    s_lshr_b32 s55, s45, 2
    s_lshl_b32 s28, s55, 3
    s_add_u32 s28, s28, s44
    s_and_b32 s29, s28, 1
    s_lshr_b32 s30, s28, 1
    s_lshl_b32 s56, s44, 3
    s_add_u32 s55, s55, s56
    s_lshl_b32 s55, s55, 7
    s_lshl_b32 s56, s31, 3
    s_add_u32 s56, s56, s3
    s_lshl_b32 s57, s56, 17
    s_add_u32 s55, s55, s57
    s_mul_i32 s56, s56, 57344
    s_lshl_b32 s57, s30, 7
    s_add_u32 s56, s56, s57
    s_lshl_b32 s57, s3, 10
    s_lshl_b32 s58, s46, 18
    s_waitcnt lgkmcnt(0)
    s_mov_b32 s16, s64
    s_mov_b32 s17, s65
    s_mov_b32 s18, 0x2000
    s_mov_b32 s19, 0x00020000
    buffer_load_dwordx4 v[48:51], v3, s[16:19], s57 offen
    s_barrier
    s_mov_b32 s20, s70
    s_mov_b32 s21, s71
    s_mov_b32 s22, 0x400000
    s_mov_b32 s23, 0x00020000
    s_lshl_b32 s63, s3, 11
    s_add_u32 m0, s63, 8448
    s_nop 0
    buffer_load_dwordx4 v13, s[20:23], s55 offen nt lds
    s_add_u32 s55, s55, 65536
    s_add_u32 m0, s63, 9472
    s_nop 0
    buffer_load_dwordx4 v13, s[20:23], s55 offen nt lds
    s_cmp_eq_u32 s29, 0
    s_cselect_b32 s24, s76, s78
    s_cselect_b32 s25, s77, s79
    s_mov_b32 s26, 0x1c0000
    s_mov_b32 s27, 0x00020000
    s_cmp_ge_u32 s28, 56
    s_cbranch_scc1 L_no_gu_ld
    s_lshl_b32 s63, s3, 11
    s_add_u32 m0, s63, 24832
    s_nop 0
    buffer_load_dwordx4 v14, s[24:27], s56 offen nt lds
    s_add_u32 s56, s56, 28672
    s_add_u32 m0, s63, 25856
    s_nop 0
    buffer_load_dwordx4 v14, s[24:27], s56 offen nt lds
L_no_gu_ld:
    s_add_u32 s4, s66, s58
    s_addc_u32 s5, s67, 0
    s_mov_b32 s6, 0x40000
    s_mov_b32 s7, 0x00020000
    s_mov_b32 s48, 0x0
    buffer_load_dwordx4 v[80:83], v1, s[4:7], s48 offen offset:0 nt
    s_add_u32 s8, s68, s58
    s_addc_u32 s9, s69, 0
    s_mov_b32 s10, 0x40000
    s_mov_b32 s11, 0x00020000
    s_load_dword s62, s[86:87], 0
    s_mov_b32 s12, s86
    s_mov_b32 s13, s87
    s_mov_b32 s14, 0x600000
    s_mov_b32 s15, 0x00020000
    s_mov_b32 s32, s80
    s_mov_b32 s33, s81
    s_mov_b32 s34, 0x1c0000
    s_mov_b32 s35, 0x00020000
    s_mov_b32 s36, s72
    s_mov_b32 s37, s73
    s_mov_b32 s38, 0x400000
    s_mov_b32 s39, 0x00020000
    s_mov_b32 s40, s82
    s_mov_b32 s41, s83
    s_mov_b32 s42, 0x2000
    s_mov_b32 s43, 0x00020000
    s_mov_b32 s50, 0x05040100
    s_mov_b32 s51, 0x07060302
    s_mov_b32 s52, 0xffffff00
    s_mov_b32 s53, 0xffff0000
    s_waitcnt lgkmcnt(0)
    s_add_u32 s47, s62, 0x0101
    s_and_b32 s55, s47, 0xffff
    v_mov_b32 v4, s55
    s_and_b32 s55, s47, 0xff
    v_mov_b32 v5, s55
    s_waitcnt vmcnt(3)
    v_lshlrev_b32 v52, 16, v48
    v_and_b32 v53, s53, v48
    v_lshlrev_b32 v54, 16, v49
    v_and_b32 v55, s53, v49
    v_lshlrev_b32 v56, 16, v50
    v_and_b32 v57, s53, v50
    v_lshlrev_b32 v58, 16, v51
    v_and_b32 v59, s53, v51
    v_add_f32 v60, v52, v53
    v_add_f32 v61, v54, v55
    v_add_f32 v62, v56, v57
    v_add_f32 v63, v58, v59
    v_add_f32 v60, v60, v61
    v_add_f32 v62, v62, v63
    v_add_f32 v60, v60, v62
    buffer_load_dwordx4 v[84:87], v1, s[4:7], s48 offen offset:1024 nt
    buffer_load_dwordx4 v[88:91], v1, s[4:7], s48 offen offset:2048 nt
    v_add_f32_dpp v60, v60, v60 row_shr:1 row_mask:0xf bank_mask:0xf bound_ctrl:0
    s_nop 1
    v_add_f32_dpp v60, v60, v60 row_shr:2 row_mask:0xf bank_mask:0xf bound_ctrl:0
    s_nop 1
    v_add_f32_dpp v60, v60, v60 row_shr:4 row_mask:0xf bank_mask:0xf bound_ctrl:0
    s_nop 1
    v_add_f32_dpp v60, v60, v60 row_shr:8 row_mask:0xf bank_mask:0xf bound_ctrl:0
    s_nop 1
    v_add_f32_dpp v60, v60, v60 row_bcast:15 row_mask:0xa bank_mask:0xf
    s_nop 1
    v_add_f32_dpp v60, v60, v60 row_bcast:31 row_mask:0xc bank_mask:0xf
    s_nop 0
    v_readlane_b32 s55, v60, 63
    s_nop 1
    v_mov_b32 v61, s55
    v_mul_f32 v61, 0x3b000000, v61
    v_sub_f32 v64, v52, v61
    v_sub_f32 v65, v53, v61
    v_sub_f32 v66, v54, v61
    v_sub_f32 v67, v55, v61
    v_sub_f32 v68, v56, v61
    v_sub_f32 v69, v57, v61
    v_sub_f32 v70, v58, v61
    v_sub_f32 v71, v59, v61
    v_mul_f32 v60, v64, v64
    v_fmac_f32 v60, v65, v65
    v_fmac_f32 v60, v66, v66
    v_fmac_f32 v60, v67, v67
    v_fmac_f32 v60, v68, v68
    v_fmac_f32 v60, v69, v69
    v_fmac_f32 v60, v70, v70
    v_fmac_f32 v60, v71, v71
    buffer_load_dwordx4 v[92:95], v1, s[4:7], s48 offen offset:3072 nt
    s_mov_b32 s48, 0x1000
    buffer_load_dwordx4 v[96:99], v1, s[4:7], s48 offen offset:0 nt
    v_add_f32_dpp v60, v60, v60 row_shr:1 row_mask:0xf bank_mask:0xf bound_ctrl:0
    s_nop 1
    v_add_f32_dpp v60, v60, v60 row_shr:2 row_mask:0xf bank_mask:0xf bound_ctrl:0
    s_nop 1
    v_add_f32_dpp v60, v60, v60 row_shr:4 row_mask:0xf bank_mask:0xf bound_ctrl:0
    s_nop 1
    v_add_f32_dpp v60, v60, v60 row_shr:8 row_mask:0xf bank_mask:0xf bound_ctrl:0
    s_nop 1
    v_add_f32_dpp v60, v60, v60 row_bcast:15 row_mask:0xa bank_mask:0xf
    s_nop 1
    v_add_f32_dpp v60, v60, v60 row_bcast:31 row_mask:0xc bank_mask:0xf
    s_nop 0
    v_readlane_b32 s56, v60, 63
    s_nop 1
    v_mov_b32 v62, s56
    v_mul_f32 v62, 0x3b000000, v62
    v_cvt_pk_bf16_f32 v62, v62, v62
    v_lshlrev_b32 v62, 16, v62
    v_add_f32 v62, 0x3727c5ac, v62
    v_cvt_pk_bf16_f32 v62, v62, v62
    v_lshlrev_b32 v62, 16, v62
    v_sqrt_f32 v62, v62
    s_nop 0
    v_cvt_pk_bf16_f32 v62, v62, v62
    v_lshlrev_b32 v62, 16, v62
    v_cvt_pk_bf16_f32 v61, v61, v61
    v_lshlrev_b32 v61, 16, v61
    v_rcp_f32 v63, v62
    s_nop 0
    v_fma_f32 v60, -v62, v63, 1.0
    v_fma_f32 v63, v60, v63, v63
    v_sub_f32 v64, v52, v61
    v_sub_f32 v65, v53, v61
    v_sub_f32 v66, v54, v61
    v_sub_f32 v67, v55, v61
    v_sub_f32 v68, v56, v61
    v_sub_f32 v69, v57, v61
    v_sub_f32 v70, v58, v61
    v_sub_f32 v71, v59, v61
    v_cvt_pk_bf16_f32 v72, v64, v65
    v_cvt_pk_bf16_f32 v73, v66, v67
    v_cvt_pk_bf16_f32 v74, v68, v69
    v_cvt_pk_bf16_f32 v75, v70, v71
    v_lshlrev_b32 v64, 16, v72
    v_and_b32 v65, s53, v72
    v_lshlrev_b32 v66, 16, v73
    v_and_b32 v67, s53, v73
    v_lshlrev_b32 v68, 16, v74
    v_and_b32 v69, s53, v74
    v_lshlrev_b32 v70, 16, v75
    v_and_b32 v71, s53, v75
    v_mul_f32 v52, v64, v63
    v_mul_f32 v53, v65, v63
    v_mul_f32 v54, v66, v63
    v_mul_f32 v55, v67, v63
    v_mul_f32 v56, v68, v63
    v_mul_f32 v57, v69, v63
    v_mul_f32 v58, v70, v63
    v_mul_f32 v59, v71, v63
    v_fma_f32 v64, -v52, v62, v64
    v_fma_f32 v65, -v53, v62, v65
    v_fma_f32 v66, -v54, v62, v66
    v_fma_f32 v67, -v55, v62, v67
    v_fma_f32 v68, -v56, v62, v68
    v_fma_f32 v69, -v57, v62, v69
    v_fma_f32 v70, -v58, v62, v70
    v_fma_f32 v71, -v59, v62, v71
    v_fma_f32 v52, v64, v63, v52
    v_fma_f32 v53, v65, v63, v53
    v_fma_f32 v54, v66, v63, v54
    v_fma_f32 v55, v67, v63, v55
    v_fma_f32 v56, v68, v63, v56
    v_fma_f32 v57, v69, v63, v57
    v_fma_f32 v58, v70, v63, v58
    v_fma_f32 v59, v71, v63, v59
    v_cvt_pk_bf16_f32 v72, v52, v53
    v_cvt_pk_bf16_f32 v73, v54, v55
    v_cvt_pk_bf16_f32 v74, v56, v57
    v_cvt_pk_bf16_f32 v75, v58, v59
    s_mul_i32 s55, s3, 1040
    v_add_u32 v60, s55, v3
    ds_write_b128 v60, v[72:75] offset:0
    buffer_load_dwordx4 v[100:103], v1, s[4:7], s48 offen offset:1024 nt
    v_and_b32 v14, 7, v0
    v_mul_u32_u24 v14, 1040, v14
    v_lshrrev_b32 v12, 4, v0
    v_lshl_add_u32 v14, v12, 4, v14
    s_lshl_b32 s55, s31, 8
    v_add_u32 v14, s55, v14
    v_lshrrev_b32 v13, 4, v0
    v_bfe_u32 v15, v0, 2, 2
    v_lshl_add_u32 v13, v13, 3, v15
    v_lshlrev_b32 v13, 7, v13
    v_and_b32 v15, 3, v0
    v_lshl_add_u32 v13, v15, 3, v13
    s_and_b32 s63, s3, 3
    s_lshl_b32 s63, s63, 5
    v_add_u32 v13, s63, v13
    s_lshl_b32 s55, s44, 2
    s_add_u32 s55, s55, s31
    s_lshl_b32 s55, s55, 11
    s_lshr_b32 s56, s45, 2
    s_lshl_b32 s56, s56, 8
    s_add_u32 s55, s55, s56
    s_add_u32 s55, s55, 0x400000
    s_lshl_b32 s56, s29, 2
    s_add_u32 s56, s56, s31
    s_mul_i32 s56, s56, 57344
    s_lshl_b32 s57, s30, 8
    s_add_u32 s56, s56, s57
    s_add_u32 s56, s56, 0x500000
    s_cmp_lt_u32 s3, 4
    s_cselect_b32 s55, s55, s56
    s_movk_i32 s63, 7168
    s_cselect_b32 s57, 65536, s63
    s_cselect_b32 s58, 0, 16384
    s_and_b32 s56, s3, 3
    s_lshl_b32 s56, s56, 6
    s_add_u32 s55, s55, s56
    v_and_b32 v20, 15, v0
    v_mul_lo_u32 v20, v20, s57
    v_lshl_add_u32 v20, v12, 4, v20
    v_add_u32 v13, s58, v13
    s_waitcnt vmcnt(6) lgkmcnt(0)
    s_barrier
    buffer_load_dwordx4 v[104:107], v1, s[4:7], s48 offen offset:2048 nt
    s_cmp_ge_u32 s28, 56
    s_cselect_b32 s56, 4, 8
    s_cmp_ge_u32 s3, s56
    s_cbranch_scc1 L_no_proj
    ds_read_b128 v[64:67], v14 offset:0
    ds_read_b128 v[68:71], v14 offset:64
    ds_read_b128 v[72:75], v14 offset:128
    ds_read_b128 v[76:79], v14 offset:192
    ds_read_b64_tr_b16 v[48:49], v13 offset:8448
    ds_read_b64_tr_b16 v[50:51], v13 offset:8960
    ds_read_b64_tr_b16 v[52:53], v13 offset:12544
    ds_read_b64_tr_b16 v[54:55], v13 offset:13056
    ds_read_b64_tr_b16 v[56:57], v13 offset:16640
    ds_read_b64_tr_b16 v[58:59], v13 offset:17152
    ds_read_b64_tr_b16 v[60:61], v13 offset:20736
    ds_read_b64_tr_b16 v[62:63], v13 offset:21248
    s_waitcnt lgkmcnt(0)
    v_mfma_f32_16x16x32_bf16 v[16:19], v[48:51], v[64:67], 0
    v_mfma_f32_16x16x32_bf16 v[16:19], v[52:55], v[68:71], v[16:19]
    v_mfma_f32_16x16x32_bf16 v[16:19], v[56:59], v[72:75], v[16:19]
    v_mfma_f32_16x16x32_bf16 v[16:19], v[60:63], v[76:79], v[16:19]
    s_mov_b32 exec_lo, 0xff00ff
    s_mov_b32 exec_hi, 0xff00ff
    s_nop 5
    v_add_u32 v16, 0x80, v16
    v_add_u32 v17, 0x80, v17
    v_add_u32 v18, 0x80, v18
    v_add_u32 v19, 0x80, v19
    v_and_or_b32 v16, v16, s52, v5
    v_and_or_b32 v17, v17, s52, v5
    v_and_or_b32 v18, v18, s52, v5
    v_and_or_b32 v19, v19, s52, v5
    buffer_store_dwordx4 v[16:19], v20, s[12:15], s55 offen sc1
    s_mov_b64 exec, -1
L_no_proj:
    s_cmp_gt_u32 s44, 3
    s_subb_u32 s55, s44, 0
    s_cmp_gt_u32 s44, 5
    s_subb_u32 s55, s55, 0
    s_mul_i32 s55, s55, 19
    s_sub_u32 s56, s45, 9
    s_add_u32 s80, s55, s56
    s_cmp_ge_u32 s56, 19
    s_cselect_b32 s80, 999, s80
    s_cmp_eq_u32 s44, 3
    s_cselect_b32 s80, 999, s80
    s_cmp_eq_u32 s44, 5
    s_cselect_b32 s80, 999, s80
    s_sub_u32 s49, s45, 28
    s_lshl_b32 s49, s49, 3
    s_add_u32 s49, s49, s44
    s_cmp_ge_u32 s45, 28
    s_cselect_b32 s49, s49, 99
    buffer_load_dwordx4 v[108:111], v1, s[4:7], s48 offen offset:3072 nt
    s_waitcnt vmcnt(6)
    s_mov_b32 s48, 0x10000
    buffer_load_dwordx4 v[112:115], v1, s[4:7], s48 offen offset:0 nt
    s_waitcnt vmcnt(6)
    buffer_load_dwordx4 v[116:119], v1, s[4:7], s48 offen offset:1024 nt
    s_waitcnt vmcnt(6)
    s_cmp_ge_u32 s80, 112
    s_cbranch_scc1 L_no_wd
    s_lshr_b32 s60, s80, 3
    s_and_b32 s81, s80, 7
    s_lshl_b32 s56, s60, 17
    s_lshl_b32 s57, s81, 7
    s_add_u32 s56, s56, s57
    s_lshl_b32 s57, s3, 14
    s_add_u32 s56, s56, s57
    v_lshrrev_b32 v12, 3, v0
    v_mul_u32_u24 v12, 1024, v12
    v_and_b32 v15, 7, v0
    v_lshl_add_u32 v12, v15, 4, v12
    s_lshl_b32 s63, s3, 11
    s_add_u32 m0, s63, 41216
    s_nop 0
    buffer_load_dwordx4 v12, s[32:35], s56 offen nt lds
    s_add_u32 s56, s56, 8192
    s_add_u32 m0, s63, 42240
    s_nop 0
    buffer_load_dwordx4 v12, s[32:35], s56 offen nt lds
    s_lshl_b32 s59, s81, 2
    s_and_b32 s55, s3, 3
    s_add_u32 s59, s59, s55
    s_lshl_b32 s59, s59, 10
    s_lshl_b32 s55, s60, 6
    s_add_u32 s59, s59, s55
    s_add_u32 s59, s59, 0x200000
    s_mul_i32 s56, s3, 7168
    s_lshl_b32 s57, s60, 9
    s_add_u32 s56, s56, s57
    s_add_u32 s61, s56, 0x40000
L_no_wd:
    buffer_load_dwordx4 v[120:123], v1, s[4:7], s48 offen offset:2048 nt
    s_waitcnt vmcnt(5)
    buffer_load_dwordx4 v[124:127], v1, s[4:7], s48 offen offset:3072 nt
    s_waitcnt vmcnt(5)
    s_cmp_ge_u32 s49, 28
    s_cbranch_scc1 L_no_gred_ld
    v_lshrrev_b32 v12, 4, v0
    v_mul_u32_u24 v12, 57344, v12
    v_and_b32 v13, 15, v0
    v_lshl_add_u32 v12, v13, 4, v12
    s_mul_i32 s56, s3, 7168
    s_lshl_b32 s57, s49, 8
    s_add_u32 s56, s56, s57
    s_add_u32 s56, s56, 0x500000
    buffer_load_dwordx4 v[16:19], v12, s[12:15], s56 offen sc1
    s_add_u32 s57, s56, 229376
    buffer_load_dwordx4 v[20:23], v12, s[12:15], s57 offen sc1
L_no_gred_ld:
    s_mov_b32 s48, 0x11000
    buffer_load_dwordx4 v[128:131], v1, s[4:7], s48 offen offset:0 nt
    s_waitcnt vmcnt(7)
    buffer_load_dwordx4 v[132:135], v1, s[4:7], s48 offen offset:1024 nt
    s_waitcnt vmcnt(7)
    buffer_load_dwordx4 v[136:139], v1, s[4:7], s48 offen offset:2048 nt
    s_waitcnt vmcnt(7)
    buffer_load_dwordx4 v[140:143], v1, s[4:7], s48 offen offset:3072 nt
    s_waitcnt vmcnt(7)
    s_mov_b32 s48, 0x20000
    buffer_load_dwordx4 v[144:147], v1, s[4:7], s48 offen offset:0 nt
    s_waitcnt vmcnt(7)
    buffer_load_dwordx4 v[148:151], v1, s[4:7], s48 offen offset:1024 nt
    s_waitcnt vmcnt(5)
    buffer_load_dwordx4 v[152:155], v1, s[4:7], s48 offen offset:2048 nt
    s_waitcnt vmcnt(5)
    s_cmp_ge_u32 s49, 28
    s_cbranch_scc1 L_no_gred
    s_waitcnt vmcnt(7)
    v_xor_b32 v16, v16, v5
    v_xor_b32 v17, v17, v5
    v_xor_b32 v18, v18, v5
    v_xor_b32 v19, v19, v5
    v_xor_b32 v20, v20, v5
    v_xor_b32 v21, v21, v5
    v_xor_b32 v22, v22, v5
    v_xor_b32 v23, v23, v5
    v_or3_b32 v48, v16, v18, v20
    v_or3_b32 v49, v17, v19, v21
    v_or_b32 v48, v48, v22
    v_or_b32 v49, v49, v23
    v_or_b32 v48, v48, v49
    v_and_b32 v48, 0xff, v48
    v_cmp_ne_u32 vcc, 0, v48
    s_cbranch_vccz L_g_ok
    v_lshrrev_b32 v12, 4, v0
    v_mul_u32_u24 v12, 57344, v12
    v_and_b32 v13, 15, v0
    v_lshl_add_u32 v12, v13, 4, v12
    s_mul_i32 s56, s3, 7168
    s_lshl_b32 s57, s49, 8
    s_add_u32 s56, s56, s57
    s_add_u32 s56, s56, 0x500000
    s_mov_b32 s54, 200000
    s_mov_b64 s[82:83], exec
L_g_retry:
    s_mov_b64 exec, vcc
    buffer_load_dwordx4 v[16:19], v12, s[12:15], s56 offen sc1
    s_add_u32 s57, s56, 229376
    buffer_load_dwordx4 v[20:23], v12, s[12:15], s57 offen sc1
    s_waitcnt vmcnt(0)
    v_xor_b32 v16, v16, v5
    v_xor_b32 v17, v17, v5
    v_xor_b32 v18, v18, v5
    v_xor_b32 v19, v19, v5
    v_xor_b32 v20, v20, v5
    v_xor_b32 v21, v21, v5
    v_xor_b32 v22, v22, v5
    v_xor_b32 v23, v23, v5
    v_or3_b32 v48, v16, v18, v20
    v_or3_b32 v49, v17, v19, v21
    v_or_b32 v48, v48, v22
    v_or_b32 v49, v49, v23
    v_or_b32 v48, v48, v49
    v_and_b32 v48, 0xff, v48
    v_cmp_ne_u32 vcc, 0, v48
    s_cbranch_vccz L_g_rest
    s_sub_u32 s54, s54, 1
    s_cmp_lg_u32 s54, 0
    s_cbranch_scc1 L_g_retry
L_g_rest:
    s_mov_b64 exec, s[82:83]
L_g_ok:
    v_permlane32_swap_b32 v16, v20
    v_permlane32_swap_b32 v17, v21
    v_permlane32_swap_b32 v18, v22
    v_permlane32_swap_b32 v19, v23
    v_add_f32 v16, v16, v20
    v_add_f32 v17, v17, v21
    v_add_f32 v18, v18, v22
    v_add_f32 v19, v19, v23
    v_permlane16_swap_b32 v16, v17
    s_nop 0
    v_permlane16_swap_b32 v18, v19
    v_add_f32 v16, v16, v17
    v_add_f32 v18, v18, v19
    v_mov_b32 v20, v16
    v_mov_b32 v21, v18
    s_nop 0
    v_permlane32_swap_b32 v16, v20
    v_permlane32_swap_b32 v18, v21
    v_cvt_pk_bf16_f32 v48, v16, v18
    v_cvt_pk_bf16_f32 v49, v20, v21
    v_lshlrev_b32 v50, 16, v48
    v_and_b32 v51, s53, v48
    v_mul_f32 v50, 0xbfb8aa3b, v50
    v_mul_f32 v51, 0xbfb8aa3b, v51
    v_exp_f32 v50, v50
    v_exp_f32 v51, v51
    v_add_f32 v50, 1.0, v50
    v_add_f32 v51, 1.0, v51
    v_rcp_f32 v50, v50
    v_rcp_f32 v51, v51
    s_nop 0
    v_cvt_pk_bf16_f32 v48, v50, v51
    v_lshlrev_b32 v50, 16, v48
    v_and_b32 v51, s53, v48
    v_lshlrev_b32 v52, 16, v49
    v_and_b32 v53, s53, v49
    v_mul_f32 v50, v50, v52
    v_mul_f32 v51, v51, v53
    v_cvt_pk_bf16_f32 v48, v50, v51
    v_lshl_or_b32 v52, v48, 16, v4
    v_and_or_b32 v54, v48, s53, v4
    v_mov_b32 v53, v52
    v_mov_b32 v55, v54
    v_mov_b32 v56, v52
    v_mov_b32 v57, v54
    s_nop 0
    v_permlane16_swap_b32 v56, v53
    v_permlane16_swap_b32 v57, v55
    s_mul_i32 s56, s3, 7168
    s_lshl_b32 s57, s49, 8
    s_add_u32 s56, s56, s57
    s_add_u32 s56, s56, 0x40000
    s_mov_b32 exec_lo, 0xffff
    s_mov_b32 exec_hi, 0x0
    buffer_store_dwordx4 v[52:55], v3, s[12:15], s56 offen sc1
    s_mov_b64 exec, -1
    s_nop 1
L_no_gred:
    buffer_load_dwordx4 v[156:159], v1, s[4:7], s48 offen offset:3072 nt
    s_waitcnt vmcnt(6)
    s_mov_b32 s48, 0x21000
    buffer_load_dwordx4 v[160:163], v1, s[4:7], s48 offen offset:0 nt
    s_waitcnt vmcnt(6)
    buffer_load_dwordx4 v[164:167], v1, s[4:7], s48 offen offset:1024 nt
    s_waitcnt vmcnt(6)
    buffer_load_dwordx4 v[168:171], v1, s[4:7], s48 offen offset:2048 nt
    s_waitcnt vmcnt(6)
    buffer_load_dwordx4 v[172:175], v1, s[4:7], s48 offen offset:3072 nt
    s_waitcnt vmcnt(6)
    s_mov_b32 s48, 0x30000
    buffer_load_dwordx4 v[176:179], v1, s[4:7], s48 offen offset:0 nt
    s_waitcnt vmcnt(5)
    buffer_load_dwordx4 v[180:183], v1, s[4:7], s48 offen offset:1024 nt
    s_waitcnt vmcnt(5)
    buffer_load_dwordx4 v[184:187], v1, s[4:7], s48 offen offset:2048 nt
    s_waitcnt vmcnt(5)
    buffer_load_dwordx4 v[188:191], v1, s[4:7], s48 offen offset:3072 nt
    s_waitcnt vmcnt(5)
    s_mov_b32 s48, 0x31000
    buffer_load_dwordx4 v[192:195], v1, s[4:7], s48 offen offset:0 nt
    s_waitcnt vmcnt(5)
    buffer_load_dwordx4 v[196:199], v1, s[4:7], s48 offen offset:1024 nt
    s_waitcnt vmcnt(5)
    buffer_load_dwordx4 v[200:203], v1, s[4:7], s48 offen offset:2048 nt
    s_waitcnt vmcnt(5)
    buffer_load_dwordx4 v[204:207], v1, s[4:7], s48 offen offset:3072 nt
    s_waitcnt vmcnt(5)
    s_lshl_b32 s55, s44, 3
    s_lshr_b32 s56, s45, 2
    s_add_u32 s55, s55, s56
    s_lshl_b32 s55, s55, 3
    s_add_u32 s55, s55, s3
    s_lshl_b32 s55, s55, 10
    s_add_u32 s55, s55, 0x400000
    buffer_load_dwordx4 v[48:51], v3, s[12:15], s55 offen sc1
    s_cmp_ge_u32 s80, 112
    s_cbranch_scc1 L_no_h_ld
    s_mov_b32 exec_lo, 0xffffffff
    s_mov_b32 exec_hi, 0x0
    buffer_load_dwordx4 v[40:43], v3, s[12:15], s61 offen sc1
    s_mov_b64 exec, -1
L_no_h_ld:
    s_mov_b32 s48, 0x0
    buffer_load_dwordx4 v[208:211], v2, s[8:11], s48 offen offset:0 nt
    s_waitcnt vmcnt(7)
    buffer_load_dwordx4 v[212:215], v2, s[8:11], s48 offen offset:1024 nt
    s_waitcnt vmcnt(7)
    buffer_load_dwordx4 v[216:219], v2, s[8:11], s48 offen offset:2048 nt
    s_waitcnt vmcnt(7)
    buffer_load_dwordx4 v[220:223], v2, s[8:11], s48 offen offset:3072 nt
    s_waitcnt vmcnt(7)
    s_mov_b32 s48, 0x1000
    buffer_load_dwordx4 v[224:227], v2, s[8:11], s48 offen offset:0 nt
    s_waitcnt vmcnt(7)
    buffer_load_dwordx4 v[228:231], v2, s[8:11], s48 offen offset:1024 nt
    s_waitcnt vmcnt(5)
    buffer_load_dwordx4 v[232:235], v2, s[8:11], s48 offen offset:2048 nt
    s_waitcnt vmcnt(5)
    buffer_load_dwordx4 v[236:239], v2, s[8:11], s48 offen offset:3072 nt
    s_waitcnt vmcnt(5)
    s_waitcnt vmcnt(8)
    v_xor_b32 v48, v48, v5
    v_xor_b32 v49, v49, v5
    v_xor_b32 v50, v50, v5
    v_xor_b32 v51, v51, v5
    v_or3_b32 v56, v48, v49, v50
    v_or_b32 v56, v56, v51
    v_and_b32 v56, 0xff, v56
    v_cmp_ne_u32 vcc, 0, v56
    s_cbranch_vccz L_q_ok
    s_lshl_b32 s55, s44, 3
    s_lshr_b32 s56, s45, 2
    s_add_u32 s55, s55, s56
    s_lshl_b32 s55, s55, 3
    s_add_u32 s55, s55, s3
    s_lshl_b32 s55, s55, 10
    s_add_u32 s55, s55, 0x400000
    s_mov_b32 s54, 200000
    s_mov_b64 s[82:83], exec
L_q_retry:
    s_mov_b64 exec, vcc
    buffer_load_dwordx4 v[48:51], v3, s[12:15], s55 offen sc1
    s_waitcnt vmcnt(0)
    v_xor_b32 v48, v48, v5
    v_xor_b32 v49, v49, v5
    v_xor_b32 v50, v50, v5
    v_xor_b32 v51, v51, v5
    v_or3_b32 v56, v48, v49, v50
    v_or_b32 v56, v56, v51
    v_and_b32 v56, 0xff, v56
    v_cmp_ne_u32 vcc, 0, v56
    s_cbranch_vccz L_q_rest
    s_sub_u32 s54, s54, 1
    s_cmp_lg_u32 s54, 0
    s_cbranch_scc1 L_q_retry
L_q_rest:
    s_mov_b64 exec, s[82:83]
L_q_ok:
    s_lshl_b32 s55, s3, 10
    s_add_u32 s55, s55, 62208
    v_add_u32 v12, s55, v3
    ds_write_b128 v12, v[48:51]
    s_cmp_ge_u32 s80, 112
    s_cbranch_scc1 L_no_t3a
    s_waitcnt vmcnt(8)
    s_mov_b32 exec_lo, 0xffffffff
    s_mov_b32 exec_hi, 0x0
    v_xor_b32 v40, v40, v4
    v_xor_b32 v41, v41, v4
    v_xor_b32 v42, v42, v4
    v_xor_b32 v43, v43, v4
    v_or3_b32 v44, v40, v41, v42
    v_or_b32 v44, v44, v43
    v_and_b32 v44, 0xffff, v44
    v_cmp_ne_u32 vcc, 0, v44
    s_cbranch_vccz L_h_ok
    s_mov_b32 s54, 200000
    s_mov_b64 s[82:83], exec
L_h_retry:
    s_mov_b64 exec, vcc
    buffer_load_dwordx4 v[40:43], v3, s[12:15], s61 offen sc1
    s_waitcnt vmcnt(0)
    v_xor_b32 v40, v40, v4
    v_xor_b32 v41, v41, v4
    v_xor_b32 v42, v42, v4
    v_xor_b32 v43, v43, v4
    v_or3_b32 v44, v40, v41, v42
    v_or_b32 v44, v44, v43
    v_and_b32 v44, 0xffff, v44
    v_cmp_ne_u32 vcc, 0, v44
    s_cbranch_vccz L_h_rest
    s_sub_u32 s54, s54, 1
    s_cmp_lg_u32 s54, 0
    s_cbranch_scc1 L_h_retry
L_h_rest:
    s_mov_b64 exec, s[82:83]
L_h_ok:
    v_perm_b32 v44, v41, v40, s51
    v_perm_b32 v45, v43, v42, s51
    s_mul_i32 s55, s3, 272
    v_lshlrev_b32 v12, 3, v0
    v_add_u32 v12, s55, v12
    ds_write_b64 v12, v[44:45] offset:60032
    s_mov_b64 exec, -1
L_no_t3a:
    v_and_b32 v13, 3, v0
    v_lshlrev_b32 v13, 9, v13
    v_lshrrev_b32 v15, 2, v0
    v_lshl_add_u32 v13, v15, 5, v13
    v_add_u32 v13, 62208, v13
    s_waitcnt lgkmcnt(0)
    s_barrier
    ds_read_b128 v[48:51], v13 offset:0
    ds_read_b128 v[52:55], v13 offset:16
    ds_read_b128 v[56:59], v13 offset:2048
    ds_read_b128 v[60:63], v13 offset:2064
    ds_read_b128 v[64:67], v13 offset:4096
    ds_read_b128 v[68:71], v13 offset:4112
    ds_read_b128 v[72:75], v13 offset:6144
    ds_read_b128 v[76:79], v13 offset:6160
    s_waitcnt lgkmcnt(0)
    v_add_f32 v48, v48, v56
    v_add_f32 v64, v64, v72
    v_add_f32 v49, v49, v57
    v_add_f32 v65, v65, v73
    v_add_f32 v50, v50, v58
    v_add_f32 v66, v66, v74
    v_add_f32 v51, v51, v59
    v_add_f32 v67, v67, v75
    v_add_f32 v52, v52, v60
    v_add_f32 v68, v68, v76
    v_add_f32 v53, v53, v61
    v_add_f32 v69, v69, v77
    v_add_f32 v54, v54, v62
    v_add_f32 v70, v70, v78
    v_add_f32 v55, v55, v63
    v_add_f32 v71, v71, v79
    v_add_f32 v48, v48, v64
    v_add_f32 v49, v49, v65
    v_add_f32 v50, v50, v66
    v_add_f32 v51, v51, v67
    v_add_f32 v52, v52, v68
    v_add_f32 v53, v53, v69
    v_add_f32 v54, v54, v70
    v_add_f32 v55, v55, v71
    v_cvt_pk_bf16_f32 v8, v48, v49
    v_cvt_pk_bf16_f32 v9, v50, v51
    v_cvt_pk_bf16_f32 v10, v52, v53
    v_cvt_pk_bf16_f32 v11, v54, v55
    s_nop 1
    v_mfma_f32_16x16x32_bf16 v[48:51], v[80:83], v[8:11], 0
    v_mfma_f32_16x16x32_bf16 v[52:55], v[84:87], v[8:11], 0
    v_mfma_f32_16x16x32_bf16 v[56:59], v[88:91], v[8:11], 0
    v_mfma_f32_16x16x32_bf16 v[60:63], v[92:95], v[8:11], 0
    v_mfma_f32_16x16x32_bf16 v[64:67], v[96:99], v[8:11], 0
    v_mfma_f32_16x16x32_bf16 v[68:71], v[100:103], v[8:11], 0
    v_mfma_f32_16x16x32_bf16 v[72:75], v[104:107], v[8:11], 0
    v_mfma_f32_16x16x32_bf16 v[76:79], v[108:111], v[8:11], 0
    s_mov_b32 s48, 0x10000
    buffer_load_dwordx4 v[80:83], v2, s[8:11], s48 offen offset:0 nt
    s_waitcnt vmcnt(5)
    buffer_load_dwordx4 v[84:87], v2, s[8:11], s48 offen offset:1024 nt
    s_waitcnt vmcnt(5)
    v_add_f32_dpp v16, v49, v48 row_shl:4 row_mask:0xf bank_mask:0xf bound_ctrl:0
    v_add_f32_dpp v17, v53, v52 row_shl:4 row_mask:0xf bank_mask:0xf bound_ctrl:0
    v_add_f32_dpp v18, v57, v56 row_shl:4 row_mask:0xf bank_mask:0xf bound_ctrl:0
    v_add_f32_dpp v19, v61, v60 row_shl:4 row_mask:0xf bank_mask:0xf bound_ctrl:0
    v_add_f32_dpp v20, v65, v64 row_shl:4 row_mask:0xf bank_mask:0xf bound_ctrl:0
    v_add_f32_dpp v21, v69, v68 row_shl:4 row_mask:0xf bank_mask:0xf bound_ctrl:0
    v_add_f32_dpp v22, v73, v72 row_shl:4 row_mask:0xf bank_mask:0xf bound_ctrl:0
    v_add_f32_dpp v23, v77, v76 row_shl:4 row_mask:0xf bank_mask:0xf bound_ctrl:0
    v_add_f32_dpp v16, v50, v16 row_shl:8 row_mask:0xf bank_mask:0xf bound_ctrl:0
    v_add_f32_dpp v17, v54, v17 row_shl:8 row_mask:0xf bank_mask:0xf bound_ctrl:0
    v_add_f32_dpp v18, v58, v18 row_shl:8 row_mask:0xf bank_mask:0xf bound_ctrl:0
    v_add_f32_dpp v19, v62, v19 row_shl:8 row_mask:0xf bank_mask:0xf bound_ctrl:0
    v_add_f32_dpp v20, v66, v20 row_shl:8 row_mask:0xf bank_mask:0xf bound_ctrl:0
    v_add_f32_dpp v21, v70, v21 row_shl:8 row_mask:0xf bank_mask:0xf bound_ctrl:0
    v_add_f32_dpp v22, v74, v22 row_shl:8 row_mask:0xf bank_mask:0xf bound_ctrl:0
    v_add_f32_dpp v23, v78, v23 row_shl:8 row_mask:0xf bank_mask:0xf bound_ctrl:0
    v_add_f32_dpp v16, v51, v16 row_shl:12 row_mask:0xf bank_mask:0xf bound_ctrl:0
    v_add_f32_dpp v17, v55, v17 row_shl:12 row_mask:0xf bank_mask:0xf bound_ctrl:0
    v_add_f32_dpp v18, v59, v18 row_shl:12 row_mask:0xf bank_mask:0xf bound_ctrl:0
    v_add_f32_dpp v19, v63, v19 row_shl:12 row_mask:0xf bank_mask:0xf bound_ctrl:0
    v_add_f32_dpp v20, v67, v20 row_shl:12 row_mask:0xf bank_mask:0xf bound_ctrl:0
    v_add_f32_dpp v21, v71, v21 row_shl:12 row_mask:0xf bank_mask:0xf bound_ctrl:0
    v_add_f32_dpp v22, v75, v22 row_shl:12 row_mask:0xf bank_mask:0xf bound_ctrl:0
    v_add_f32_dpp v23, v79, v23 row_shl:12 row_mask:0xf bank_mask:0xf bound_ctrl:0
    v_mfma_f32_16x16x32_bf16 v[48:51], v[112:115], v[8:11], 0
    v_mfma_f32_16x16x32_bf16 v[52:55], v[116:119], v[8:11], 0
    v_mfma_f32_16x16x32_bf16 v[56:59], v[120:123], v[8:11], 0
    v_mfma_f32_16x16x32_bf16 v[60:63], v[124:127], v[8:11], 0
    v_mfma_f32_16x16x32_bf16 v[64:67], v[128:131], v[8:11], 0
    v_mfma_f32_16x16x32_bf16 v[68:71], v[132:135], v[8:11], 0
    v_mfma_f32_16x16x32_bf16 v[72:75], v[136:139], v[8:11], 0
    v_mfma_f32_16x16x32_bf16 v[76:79], v[140:143], v[8:11], 0
    buffer_load_dwordx4 v[88:91], v2, s[8:11], s48 offen offset:2048 nt
    s_waitcnt vmcnt(5)
    buffer_load_dwordx4 v[92:95], v2, s[8:11], s48 offen offset:3072 nt
    s_waitcnt vmcnt(5)
    v_add_f32_dpp v24, v49, v48 row_shl:4 row_mask:0xf bank_mask:0xf bound_ctrl:0
    v_add_f32_dpp v25, v53, v52 row_shl:4 row_mask:0xf bank_mask:0xf bound_ctrl:0
    v_add_f32_dpp v26, v57, v56 row_shl:4 row_mask:0xf bank_mask:0xf bound_ctrl:0
    v_add_f32_dpp v27, v61, v60 row_shl:4 row_mask:0xf bank_mask:0xf bound_ctrl:0
    v_add_f32_dpp v28, v65, v64 row_shl:4 row_mask:0xf bank_mask:0xf bound_ctrl:0
    v_add_f32_dpp v29, v69, v68 row_shl:4 row_mask:0xf bank_mask:0xf bound_ctrl:0
    v_add_f32_dpp v30, v73, v72 row_shl:4 row_mask:0xf bank_mask:0xf bound_ctrl:0
    v_add_f32_dpp v31, v77, v76 row_shl:4 row_mask:0xf bank_mask:0xf bound_ctrl:0
    v_add_f32_dpp v24, v50, v24 row_shl:8 row_mask:0xf bank_mask:0xf bound_ctrl:0
    v_add_f32_dpp v25, v54, v25 row_shl:8 row_mask:0xf bank_mask:0xf bound_ctrl:0
    v_add_f32_dpp v26, v58, v26 row_shl:8 row_mask:0xf bank_mask:0xf bound_ctrl:0
    v_add_f32_dpp v27, v62, v27 row_shl:8 row_mask:0xf bank_mask:0xf bound_ctrl:0
    v_add_f32_dpp v28, v66, v28 row_shl:8 row_mask:0xf bank_mask:0xf bound_ctrl:0
    v_add_f32_dpp v29, v70, v29 row_shl:8 row_mask:0xf bank_mask:0xf bound_ctrl:0
    v_add_f32_dpp v30, v74, v30 row_shl:8 row_mask:0xf bank_mask:0xf bound_ctrl:0
    v_add_f32_dpp v31, v78, v31 row_shl:8 row_mask:0xf bank_mask:0xf bound_ctrl:0
    v_add_f32_dpp v24, v51, v24 row_shl:12 row_mask:0xf bank_mask:0xf bound_ctrl:0
    v_add_f32_dpp v25, v55, v25 row_shl:12 row_mask:0xf bank_mask:0xf bound_ctrl:0
    v_add_f32_dpp v26, v59, v26 row_shl:12 row_mask:0xf bank_mask:0xf bound_ctrl:0
    v_add_f32_dpp v27, v63, v27 row_shl:12 row_mask:0xf bank_mask:0xf bound_ctrl:0
    v_add_f32_dpp v28, v67, v28 row_shl:12 row_mask:0xf bank_mask:0xf bound_ctrl:0
    v_add_f32_dpp v29, v71, v29 row_shl:12 row_mask:0xf bank_mask:0xf bound_ctrl:0
    v_add_f32_dpp v30, v75, v30 row_shl:12 row_mask:0xf bank_mask:0xf bound_ctrl:0
    v_add_f32_dpp v31, v79, v31 row_shl:12 row_mask:0xf bank_mask:0xf bound_ctrl:0
    v_mfma_f32_16x16x32_bf16 v[48:51], v[144:147], v[8:11], 0
    v_mfma_f32_16x16x32_bf16 v[52:55], v[148:151], v[8:11], 0
    v_mfma_f32_16x16x32_bf16 v[56:59], v[152:155], v[8:11], 0
    v_mfma_f32_16x16x32_bf16 v[60:63], v[156:159], v[8:11], 0
    v_mfma_f32_16x16x32_bf16 v[64:67], v[160:163], v[8:11], 0
    v_mfma_f32_16x16x32_bf16 v[68:71], v[164:167], v[8:11], 0
    v_mfma_f32_16x16x32_bf16 v[72:75], v[168:171], v[8:11], 0
    v_mfma_f32_16x16x32_bf16 v[76:79], v[172:175], v[8:11], 0
    s_mov_b32 s48, 0x11000
    buffer_load_dwordx4 v[96:99], v2, s[8:11], s48 offen offset:0 nt
    s_waitcnt vmcnt(5)
    buffer_load_dwordx4 v[100:103], v2, s[8:11], s48 offen offset:1024 nt
    s_waitcnt vmcnt(5)
    v_add_f32_dpp v32, v49, v48 row_shl:4 row_mask:0xf bank_mask:0xf bound_ctrl:0
    v_add_f32_dpp v33, v53, v52 row_shl:4 row_mask:0xf bank_mask:0xf bound_ctrl:0
    v_add_f32_dpp v34, v57, v56 row_shl:4 row_mask:0xf bank_mask:0xf bound_ctrl:0
    v_add_f32_dpp v35, v61, v60 row_shl:4 row_mask:0xf bank_mask:0xf bound_ctrl:0
    v_add_f32_dpp v36, v65, v64 row_shl:4 row_mask:0xf bank_mask:0xf bound_ctrl:0
    v_add_f32_dpp v37, v69, v68 row_shl:4 row_mask:0xf bank_mask:0xf bound_ctrl:0
    v_add_f32_dpp v38, v73, v72 row_shl:4 row_mask:0xf bank_mask:0xf bound_ctrl:0
    v_add_f32_dpp v39, v77, v76 row_shl:4 row_mask:0xf bank_mask:0xf bound_ctrl:0
    v_add_f32_dpp v32, v50, v32 row_shl:8 row_mask:0xf bank_mask:0xf bound_ctrl:0
    v_add_f32_dpp v33, v54, v33 row_shl:8 row_mask:0xf bank_mask:0xf bound_ctrl:0
    v_add_f32_dpp v34, v58, v34 row_shl:8 row_mask:0xf bank_mask:0xf bound_ctrl:0
    v_add_f32_dpp v35, v62, v35 row_shl:8 row_mask:0xf bank_mask:0xf bound_ctrl:0
    v_add_f32_dpp v36, v66, v36 row_shl:8 row_mask:0xf bank_mask:0xf bound_ctrl:0
    v_add_f32_dpp v37, v70, v37 row_shl:8 row_mask:0xf bank_mask:0xf bound_ctrl:0
    v_add_f32_dpp v38, v74, v38 row_shl:8 row_mask:0xf bank_mask:0xf bound_ctrl:0
    v_add_f32_dpp v39, v78, v39 row_shl:8 row_mask:0xf bank_mask:0xf bound_ctrl:0
    v_add_f32_dpp v32, v51, v32 row_shl:12 row_mask:0xf bank_mask:0xf bound_ctrl:0
    v_add_f32_dpp v33, v55, v33 row_shl:12 row_mask:0xf bank_mask:0xf bound_ctrl:0
    v_add_f32_dpp v34, v59, v34 row_shl:12 row_mask:0xf bank_mask:0xf bound_ctrl:0
    v_add_f32_dpp v35, v63, v35 row_shl:12 row_mask:0xf bank_mask:0xf bound_ctrl:0
    v_add_f32_dpp v36, v67, v36 row_shl:12 row_mask:0xf bank_mask:0xf bound_ctrl:0
    v_add_f32_dpp v37, v71, v37 row_shl:12 row_mask:0xf bank_mask:0xf bound_ctrl:0
    v_add_f32_dpp v38, v75, v38 row_shl:12 row_mask:0xf bank_mask:0xf bound_ctrl:0
    v_add_f32_dpp v39, v79, v39 row_shl:12 row_mask:0xf bank_mask:0xf bound_ctrl:0
    v_mfma_f32_16x16x32_bf16 v[48:51], v[176:179], v[8:11], 0
    v_mfma_f32_16x16x32_bf16 v[52:55], v[180:183], v[8:11], 0
    v_mfma_f32_16x16x32_bf16 v[56:59], v[184:187], v[8:11], 0
    v_mfma_f32_16x16x32_bf16 v[60:63], v[188:191], v[8:11], 0
    v_mfma_f32_16x16x32_bf16 v[64:67], v[192:195], v[8:11], 0
    v_mfma_f32_16x16x32_bf16 v[68:71], v[196:199], v[8:11], 0
    v_mfma_f32_16x16x32_bf16 v[72:75], v[200:203], v[8:11], 0
    v_mfma_f32_16x16x32_bf16 v[76:79], v[204:207], v[8:11], 0
    buffer_load_dwordx4 v[104:107], v2, s[8:11], s48 offen offset:2048 nt
    s_waitcnt vmcnt(5)
    buffer_load_dwordx4 v[108:111], v2, s[8:11], s48 offen offset:3072 nt
    s_waitcnt vmcnt(5)
    v_add_f32_dpp v40, v49, v48 row_shl:4 row_mask:0xf bank_mask:0xf bound_ctrl:0
    v_add_f32_dpp v41, v53, v52 row_shl:4 row_mask:0xf bank_mask:0xf bound_ctrl:0
    v_add_f32_dpp v42, v57, v56 row_shl:4 row_mask:0xf bank_mask:0xf bound_ctrl:0
    v_add_f32_dpp v43, v61, v60 row_shl:4 row_mask:0xf bank_mask:0xf bound_ctrl:0
    v_add_f32_dpp v44, v65, v64 row_shl:4 row_mask:0xf bank_mask:0xf bound_ctrl:0
    v_add_f32_dpp v45, v69, v68 row_shl:4 row_mask:0xf bank_mask:0xf bound_ctrl:0
    v_add_f32_dpp v46, v73, v72 row_shl:4 row_mask:0xf bank_mask:0xf bound_ctrl:0
    v_add_f32_dpp v47, v77, v76 row_shl:4 row_mask:0xf bank_mask:0xf bound_ctrl:0
    v_add_f32_dpp v40, v50, v40 row_shl:8 row_mask:0xf bank_mask:0xf bound_ctrl:0
    v_add_f32_dpp v41, v54, v41 row_shl:8 row_mask:0xf bank_mask:0xf bound_ctrl:0
    v_add_f32_dpp v42, v58, v42 row_shl:8 row_mask:0xf bank_mask:0xf bound_ctrl:0
    v_add_f32_dpp v43, v62, v43 row_shl:8 row_mask:0xf bank_mask:0xf bound_ctrl:0
    v_add_f32_dpp v44, v66, v44 row_shl:8 row_mask:0xf bank_mask:0xf bound_ctrl:0
    v_add_f32_dpp v45, v70, v45 row_shl:8 row_mask:0xf bank_mask:0xf bound_ctrl:0
    v_add_f32_dpp v46, v74, v46 row_shl:8 row_mask:0xf bank_mask:0xf bound_ctrl:0
    v_add_f32_dpp v47, v78, v47 row_shl:8 row_mask:0xf bank_mask:0xf bound_ctrl:0
    v_add_f32_dpp v40, v51, v40 row_shl:12 row_mask:0xf bank_mask:0xf bound_ctrl:0
    v_add_f32_dpp v41, v55, v41 row_shl:12 row_mask:0xf bank_mask:0xf bound_ctrl:0
    v_add_f32_dpp v42, v59, v42 row_shl:12 row_mask:0xf bank_mask:0xf bound_ctrl:0
    v_add_f32_dpp v43, v63, v43 row_shl:12 row_mask:0xf bank_mask:0xf bound_ctrl:0
    v_add_f32_dpp v44, v67, v44 row_shl:12 row_mask:0xf bank_mask:0xf bound_ctrl:0
    v_add_f32_dpp v45, v71, v45 row_shl:12 row_mask:0xf bank_mask:0xf bound_ctrl:0
    v_add_f32_dpp v46, v75, v46 row_shl:12 row_mask:0xf bank_mask:0xf bound_ctrl:0
    v_add_f32_dpp v47, v79, v47 row_shl:12 row_mask:0xf bank_mask:0xf bound_ctrl:0
    s_cmp_ge_u32 s80, 112
    s_cbranch_scc1 L_no_t3b
    s_cmp_ge_u32 s3, 4
    s_cbranch_scc1 L_no_t3b
    v_lshrrev_b32 v12, 4, v0
    v_bfe_u32 v15, v0, 2, 2
    v_lshl_add_u32 v12, v12, 3, v15
    v_lshlrev_b32 v12, 7, v12
    v_and_b32 v15, 3, v0
    v_lshl_add_u32 v12, v15, 3, v12
    s_and_b32 s63, s3, 3
    s_lshl_b32 s63, s63, 5
    v_add_u32 v12, s63, v12
    v_and_b32 v13, 7, v0
    v_mul_u32_u24 v13, 272, v13
    v_lshrrev_b32 v14, 4, v0
    v_lshl_add_u32 v13, v14, 4, v13
    v_lshlrev_b32 v14, 4, v14
    v_and_b32 v15, 15, v0
    v_mul_u32_u24 v15, 32768, v15
    v_add_u32 v14, v14, v15
    ds_read_b64_tr_b16 v[48:49], v12 offset:41216
    ds_read_b64_tr_b16 v[50:51], v12 offset:41728
    ds_read_b64_tr_b16 v[52:53], v12 offset:45312
    ds_read_b64_tr_b16 v[54:55], v12 offset:45824
    ds_read_b64_tr_b16 v[56:57], v12 offset:49408
    ds_read_b64_tr_b16 v[58:59], v12 offset:49920
    ds_read_b64_tr_b16 v[60:61], v12 offset:53504
    ds_read_b64_tr_b16 v[62:63], v12 offset:54016
    ds_read_b128 v[64:67], v13 offset:60032
    ds_read_b128 v[68:71], v13 offset:60096
    ds_read_b128 v[72:75], v13 offset:60160
    ds_read_b128 v[76:79], v13 offset:60224
    s_waitcnt lgkmcnt(0)
    v_mfma_f32_16x16x32_bf16 v[176:179], v[48:51], v[64:67], 0
    v_mfma_f32_16x16x32_bf16 v[176:179], v[52:55], v[68:71], v[176:179]
    v_mfma_f32_16x16x32_bf16 v[176:179], v[56:59], v[72:75], v[176:179]
    v_mfma_f32_16x16x32_bf16 v[176:179], v[60:63], v[76:79], v[176:179]
    s_mov_b32 exec_lo, 0xff00ff
    s_mov_b32 exec_hi, 0xff00ff
    s_nop 5
    v_add_u32 v176, 0x80, v176
    v_add_u32 v177, 0x80, v177
    v_add_u32 v178, 0x80, v178
    v_add_u32 v179, 0x80, v179
    v_and_or_b32 v176, v176, s52, v5
    v_and_or_b32 v177, v177, s52, v5
    v_and_or_b32 v178, v178, s52, v5
    v_and_or_b32 v179, v179, s52, v5
    buffer_store_dwordx4 v[176:179], v14, s[12:15], s59 offen sc1
    s_mov_b64 exec, -1
    s_nop 1
L_no_t3b:
    s_mov_b32 s48, 0x20000
    buffer_load_dwordx4 v[112:115], v2, s[8:11], s48 offen offset:0 nt
    s_waitcnt vmcnt(6)
    buffer_load_dwordx4 v[116:119], v2, s[8:11], s48 offen offset:1024 nt
    s_waitcnt vmcnt(6)
    s_mov_b32 s55, 0x3db504f3
    v_cvt_pk_bf16_f32 v48, v16, v17
    v_cvt_pk_bf16_f32 v49, v18, v19
    v_cvt_pk_bf16_f32 v50, v20, v21
    v_cvt_pk_bf16_f32 v51, v22, v23
    v_cvt_pk_bf16_f32 v52, v24, v25
    v_cvt_pk_bf16_f32 v53, v26, v27
    v_cvt_pk_bf16_f32 v54, v28, v29
    v_cvt_pk_bf16_f32 v55, v30, v31
    v_cvt_pk_bf16_f32 v56, v32, v33
    v_cvt_pk_bf16_f32 v57, v34, v35
    v_cvt_pk_bf16_f32 v58, v36, v37
    v_cvt_pk_bf16_f32 v59, v38, v39
    v_cvt_pk_bf16_f32 v60, v40, v41
    v_cvt_pk_bf16_f32 v61, v42, v43
    v_cvt_pk_bf16_f32 v62, v44, v45
    v_cvt_pk_bf16_f32 v63, v46, v47
    v_lshlrev_b32 v16, 16, v48
    v_and_b32 v17, s53, v48
    v_lshlrev_b32 v18, 16, v49
    v_and_b32 v19, s53, v49
    v_lshlrev_b32 v20, 16, v50
    v_and_b32 v21, s53, v50
    v_lshlrev_b32 v22, 16, v51
    v_and_b32 v23, s53, v51
    v_lshlrev_b32 v24, 16, v52
    v_and_b32 v25, s53, v52
    v_lshlrev_b32 v26, 16, v53
    v_and_b32 v27, s53, v53
    v_lshlrev_b32 v28, 16, v54
    v_and_b32 v29, s53, v54
    v_lshlrev_b32 v30, 16, v55
    v_and_b32 v31, s53, v55
    v_lshlrev_b32 v32, 16, v56
    v_and_b32 v33, s53, v56
    v_lshlrev_b32 v34, 16, v57
    v_and_b32 v35, s53, v57
    v_lshlrev_b32 v36, 16, v58
    v_and_b32 v37, s53, v58
    v_lshlrev_b32 v38, 16, v59
    v_and_b32 v39, s53, v59
    v_lshlrev_b32 v40, 16, v60
    v_and_b32 v41, s53, v60
    v_lshlrev_b32 v42, 16, v61
    v_and_b32 v43, s53, v61
    v_lshlrev_b32 v44, 16, v62
    v_and_b32 v45, s53, v62
    v_lshlrev_b32 v46, 16, v63
    v_and_b32 v47, s53, v63
    v_mul_f32 v16, s55, v16
    v_mul_f32 v17, s55, v17
    v_mul_f32 v18, s55, v18
    v_mul_f32 v19, s55, v19
    v_mul_f32 v20, s55, v20
    v_mul_f32 v21, s55, v21
    v_mul_f32 v22, s55, v22
    v_mul_f32 v23, s55, v23
    v_mul_f32 v24, s55, v24
    v_mul_f32 v25, s55, v25
    v_mul_f32 v26, s55, v26
    v_mul_f32 v27, s55, v27
    v_mul_f32 v28, s55, v28
    v_mul_f32 v29, s55, v29
    v_mul_f32 v30, s55, v30
    v_mul_f32 v31, s55, v31
    v_mul_f32 v32, s55, v32
    v_mul_f32 v33, s55, v33
    v_mul_f32 v34, s55, v34
    v_mul_f32 v35, s55, v35
    v_mul_f32 v36, s55, v36
    v_mul_f32 v37, s55, v37
    v_mul_f32 v38, s55, v38
    v_mul_f32 v39, s55, v39
    v_mul_f32 v40, s55, v40
    v_mul_f32 v41, s55, v41
    v_mul_f32 v42, s55, v42
    v_mul_f32 v43, s55, v43
    v_mul_f32 v44, s55, v44
    v_mul_f32 v45, s55, v45
    v_mul_f32 v46, s55, v46
    v_mul_f32 v47, s55, v47
    buffer_load_dwordx4 v[120:123], v2, s[8:11], s48 offen offset:2048 nt
    s_waitcnt vmcnt(6)
    v_cvt_pk_bf16_f32 v48, v16, v17
    v_cvt_pk_bf16_f32 v49, v18, v19
    v_cvt_pk_bf16_f32 v50, v20, v21
    v_cvt_pk_bf16_f32 v51, v22, v23
    v_cvt_pk_bf16_f32 v52, v24, v25
    v_cvt_pk_bf16_f32 v53, v26, v27
    v_cvt_pk_bf16_f32 v54, v28, v29
    v_cvt_pk_bf16_f32 v55, v30, v31
    v_cvt_pk_bf16_f32 v56, v32, v33
    v_cvt_pk_bf16_f32 v57, v34, v35
    v_cvt_pk_bf16_f32 v58, v36, v37
    v_cvt_pk_bf16_f32 v59, v38, v39
    v_cvt_pk_bf16_f32 v60, v40, v41
    v_cvt_pk_bf16_f32 v61, v42, v43
    v_cvt_pk_bf16_f32 v62, v44, v45
    v_cvt_pk_bf16_f32 v63, v46, v47
    v_lshlrev_b32 v16, 16, v48
    v_and_b32 v17, s53, v48
    v_lshlrev_b32 v18, 16, v49
    v_and_b32 v19, s53, v49
    v_lshlrev_b32 v20, 16, v50
    v_and_b32 v21, s53, v50
    v_lshlrev_b32 v22, 16, v51
    v_and_b32 v23, s53, v51
    v_lshlrev_b32 v24, 16, v52
    v_and_b32 v25, s53, v52
    v_lshlrev_b32 v26, 16, v53
    v_and_b32 v27, s53, v53
    v_lshlrev_b32 v28, 16, v54
    v_and_b32 v29, s53, v54
    v_lshlrev_b32 v30, 16, v55
    v_and_b32 v31, s53, v55
    v_lshlrev_b32 v32, 16, v56
    v_and_b32 v33, s53, v56
    v_lshlrev_b32 v34, 16, v57
    v_and_b32 v35, s53, v57
    v_lshlrev_b32 v36, 16, v58
    v_and_b32 v37, s53, v58
    v_lshlrev_b32 v38, 16, v59
    v_and_b32 v39, s53, v59
    v_lshlrev_b32 v40, 16, v60
    v_and_b32 v41, s53, v60
    v_lshlrev_b32 v42, 16, v61
    v_and_b32 v43, s53, v61
    v_lshlrev_b32 v44, 16, v62
    v_and_b32 v45, s53, v62
    v_lshlrev_b32 v46, 16, v63
    v_and_b32 v47, s53, v63
    buffer_load_dwordx4 v[124:127], v2, s[8:11], s48 offen offset:3072 nt
    s_waitcnt vmcnt(6)
    v_max3_f32 v12, v16, v17, v18
    v_max3_f32 v12, v12, v19, v20
    v_max3_f32 v12, v12, v21, v22
    v_max3_f32 v12, v12, v23, v24
    v_max3_f32 v12, v12, v25, v26
    v_max3_f32 v12, v12, v27, v28
    v_max3_f32 v12, v12, v29, v30
    v_max3_f32 v12, v12, v31, v32
    v_max3_f32 v12, v12, v33, v34
    v_max3_f32 v12, v12, v35, v36
    v_max3_f32 v12, v12, v37, v38
    v_max3_f32 v12, v12, v39, v40
    v_max3_f32 v12, v12, v41, v42
    v_max3_f32 v12, v12, v43, v44
    v_max3_f32 v12, v12, v45, v46
    v_max_f32 v12, v12, v47
    v_mov_b32 v13, v12
    s_nop 1
    v_permlane16_swap_b32 v12, v13
    v_max_f32 v12, v12, v13
    v_mov_b32 v13, v12
    s_nop 1
    v_permlane32_swap_b32 v12, v13
    v_max_f32 v12, v12, v13
    s_lshl_b32 s55, s3, 4
    v_and_b32 v14, 3, v0
    v_lshlrev_b32 v14, 2, v14
    v_add_u32 v15, s55, v14
    s_mov_b32 exec_lo, 0xf
    s_mov_b32 exec_hi, 0x0
    ds_write_b32 v15, v12 offset:57600
    s_mov_b64 exec, -1
    s_waitcnt lgkmcnt(0)
    s_barrier
    ds_read_b32 v48, v14 offset:57600
    ds_read_b32 v49, v14 offset:57616
    ds_read_b32 v50, v14 offset:57632
    ds_read_b32 v51, v14 offset:57648
    ds_read_b32 v52, v14 offset:57664
    ds_read_b32 v53, v14 offset:57680
    ds_read_b32 v54, v14 offset:57696
    ds_read_b32 v55, v14 offset:57712
    s_mov_b32 s48, 0x21000
    buffer_load_dwordx4 v[128:131], v2, s[8:11], s48 offen offset:0 nt
    s_waitcnt vmcnt(6)
    s_waitcnt lgkmcnt(0)
    v_max3_f32 v12, v48, v49, v50
    v_max3_f32 v12, v12, v51, v52
    v_max3_f32 v12, v12, v53, v54
    v_max_f32 v12, v12, v55
    s_mov_b32 s55, 0x3fb8aa3b
    v_mul_f32 v12, s55, v12
    v_and_b32 v7, s52, v12
    v_sub_f32 v6, 0, v7
    v_fma_f32 v16, v16, s55, v6
    v_fma_f32 v17, v17, s55, v6
    v_fma_f32 v18, v18, s55, v6
    v_fma_f32 v19, v19, s55, v6
    v_fma_f32 v20, v20, s55, v6
    v_fma_f32 v21, v21, s55, v6
    v_fma_f32 v22, v22, s55, v6
    v_fma_f32 v23, v23, s55, v6
    v_fma_f32 v24, v24, s55, v6
    v_fma_f32 v25, v25, s55, v6
    v_fma_f32 v26, v26, s55, v6
    v_fma_f32 v27, v27, s55, v6
    v_fma_f32 v28, v28, s55, v6
    v_fma_f32 v29, v29, s55, v6
    v_fma_f32 v30, v30, s55, v6
    v_fma_f32 v31, v31, s55, v6
    v_fma_f32 v32, v32, s55, v6
    v_fma_f32 v33, v33, s55, v6
    v_fma_f32 v34, v34, s55, v6
    v_fma_f32 v35, v35, s55, v6
    v_fma_f32 v36, v36, s55, v6
    v_fma_f32 v37, v37, s55, v6
    v_fma_f32 v38, v38, s55, v6
    v_fma_f32 v39, v39, s55, v6
    v_fma_f32 v40, v40, s55, v6
    v_fma_f32 v41, v41, s55, v6
    v_fma_f32 v42, v42, s55, v6
    v_fma_f32 v43, v43, s55, v6
    v_fma_f32 v44, v44, s55, v6
    v_fma_f32 v45, v45, s55, v6
    v_fma_f32 v46, v46, s55, v6
    v_fma_f32 v47, v47, s55, v6
    buffer_load_dwordx4 v[132:135], v2, s[8:11], s48 offen offset:1024 nt
    s_waitcnt vmcnt(5)
    v_exp_f32 v16, v16
    v_exp_f32 v17, v17
    v_exp_f32 v18, v18
    v_exp_f32 v19, v19
    v_exp_f32 v20, v20
    v_exp_f32 v21, v21
    v_exp_f32 v22, v22
    v_exp_f32 v23, v23
    v_exp_f32 v24, v24
    v_exp_f32 v25, v25
    v_exp_f32 v26, v26
    v_exp_f32 v27, v27
    v_exp_f32 v28, v28
    v_exp_f32 v29, v29
    v_exp_f32 v30, v30
    v_exp_f32 v31, v31
    v_exp_f32 v32, v32
    v_exp_f32 v33, v33
    v_exp_f32 v34, v34
    v_exp_f32 v35, v35
    v_exp_f32 v36, v36
    v_exp_f32 v37, v37
    v_exp_f32 v38, v38
    v_exp_f32 v39, v39
    v_exp_f32 v40, v40
    v_exp_f32 v41, v41
    v_exp_f32 v42, v42
    v_exp_f32 v43, v43
    v_exp_f32 v44, v44
    v_exp_f32 v45, v45
    v_exp_f32 v46, v46
    v_exp_f32 v47, v47
    buffer_load_dwordx4 v[136:139], v2, s[8:11], s48 offen offset:2048 nt
    s_waitcnt vmcnt(5)
    v_add_f32 v12, v16, v17
    v_add_f32 v13, v18, v19
    v_add_f32 v12, v12, v20
    v_add_f32 v13, v13, v21
    v_add_f32 v12, v12, v22
    v_add_f32 v13, v13, v23
    v_add_f32 v12, v12, v24
    v_add_f32 v13, v13, v25
    v_add_f32 v12, v12, v26
    v_add_f32 v13, v13, v27
    v_add_f32 v12, v12, v28
    v_add_f32 v13, v13, v29
    v_add_f32 v12, v12, v30
    v_add_f32 v13, v13, v31
    v_add_f32 v12, v12, v32
    v_add_f32 v13, v13, v33
    v_add_f32 v12, v12, v34
    v_add_f32 v13, v13, v35
    v_add_f32 v12, v12, v36
    v_add_f32 v13, v13, v37
    v_add_f32 v12, v12, v38
    v_add_f32 v13, v13, v39
    v_add_f32 v12, v12, v40
    v_add_f32 v13, v13, v41
    v_add_f32 v12, v12, v42
    v_add_f32 v13, v13, v43
    v_add_f32 v12, v12, v44
    v_add_f32 v13, v13, v45
    v_add_f32 v12, v12, v46
    v_add_f32 v13, v13, v47
    v_add_f32 v12, v12, v13
    v_cvt_pk_bf16_f32 v16, v16, v17
    v_cvt_pk_bf16_f32 v17, v18, v19
    v_cvt_pk_bf16_f32 v18, v20, v21
    v_cvt_pk_bf16_f32 v19, v22, v23
    v_cvt_pk_bf16_f32 v20, v24, v25
    v_cvt_pk_bf16_f32 v21, v26, v27
    v_cvt_pk_bf16_f32 v22, v28, v29
    v_cvt_pk_bf16_f32 v23, v30, v31
    v_cvt_pk_bf16_f32 v24, v32, v33
    v_cvt_pk_bf16_f32 v25, v34, v35
    v_cvt_pk_bf16_f32 v26, v36, v37
    v_cvt_pk_bf16_f32 v27, v38, v39
    v_cvt_pk_bf16_f32 v28, v40, v41
    v_cvt_pk_bf16_f32 v29, v42, v43
    v_cvt_pk_bf16_f32 v30, v44, v45
    v_cvt_pk_bf16_f32 v31, v46, v47
    v_mov_b32 v13, v12
    s_nop 1
    v_permlane16_swap_b32 v12, v13
    v_add_f32 v12, v12, v13
    v_mov_b32 v13, v12
    s_nop 1
    v_permlane32_swap_b32 v12, v13
    v_add_f32 v12, v12, v13
    s_mov_b32 exec_lo, 0xf
    s_mov_b32 exec_hi, 0x0
    ds_write_b32 v15, v12 offset:57728
    s_mov_b64 exec, -1
    buffer_load_dwordx4 v[140:143], v2, s[8:11], s48 offen offset:3072 nt
    s_waitcnt vmcnt(5)
    s_waitcnt lgkmcnt(0)
    s_barrier
    s_cmp_lg_u32 s3, 3
    s_cbranch_scc1 L_no_ml
    v_mov_b32 v12, 0
    ds_read_b128 v[48:51], v12 offset:57728
    ds_read_b128 v[52:55], v12 offset:57744
    ds_read_b128 v[56:59], v12 offset:57760
    ds_read_b128 v[60:63], v12 offset:57776
    ds_read_b128 v[64:67], v12 offset:57792
    ds_read_b128 v[68:71], v12 offset:57808
    ds_read_b128 v[72:75], v12 offset:57824
    ds_read_b128 v[76:79], v12 offset:57840
    s_waitcnt lgkmcnt(0)
    v_add_f32 v48, v48, v52
    v_add_f32 v49, v49, v53
    v_add_f32 v50, v50, v54
    v_add_f32 v51, v51, v55
    v_add_f32 v48, v48, v56
    v_add_f32 v49, v49, v57
    v_add_f32 v50, v50, v58
    v_add_f32 v51, v51, v59
    v_add_f32 v48, v48, v60
    v_add_f32 v49, v49, v61
    v_add_f32 v50, v50, v62
    v_add_f32 v51, v51, v63
    v_add_f32 v48, v48, v64
    v_add_f32 v49, v49, v65
    v_add_f32 v50, v50, v66
    v_add_f32 v51, v51, v67
    v_add_f32 v48, v48, v68
    v_add_f32 v49, v49, v69
    v_add_f32 v50, v50, v70
    v_add_f32 v51, v51, v71
    v_add_f32 v48, v48, v72
    v_add_f32 v49, v49, v73
    v_add_f32 v50, v50, v74
    v_add_f32 v51, v51, v75
    v_add_f32 v48, v48, v76
    v_add_f32 v49, v49, v77
    v_add_f32 v50, v50, v78
    v_add_f32 v51, v51, v79
    v_readlane_b32 s55, v7, 0
    v_readlane_b32 s56, v7, 1
    v_readlane_b32 s57, v7, 2
    v_readlane_b32 s58, v7, 3
    v_or_b32 v52, s55, v5
    v_or_b32 v53, s56, v5
    v_or_b32 v54, s57, v5
    v_or_b32 v55, s58, v5
    v_and_or_b32 v48, v48, s52, v5
    v_and_or_b32 v49, v49, s52, v5
    v_and_or_b32 v50, v50, s52, v5
    v_and_or_b32 v51, v51, s52, v5
    s_lshl_b32 s55, s46, 5
    s_add_u32 s55, s55, 0x50000
    s_mov_b32 exec_lo, 0x1
    s_mov_b32 exec_hi, 0x0
    buffer_store_dwordx4 v[52:55], v12, s[12:15], s55 offen sc1
    buffer_store_dwordx4 v[48:51], v12, s[12:15], s55 offen offset:16 sc1
    s_mov_b64 exec, -1
    s_nop 1
L_no_ml:
    s_waitcnt vmcnt(16)
    v_perm_b32 v32, v212, v208, s50
    v_perm_b32 v33, v220, v216, s50
    v_perm_b32 v34, v228, v224, s50
    v_perm_b32 v35, v236, v232, s50
    v_perm_b32 v36, v212, v208, s51
    v_perm_b32 v37, v220, v216, s51
    v_perm_b32 v38, v228, v224, s51
    v_perm_b32 v39, v236, v232, s51
    v_mfma_f32_16x16x32_bf16 v[48:51], v[16:19], v[32:35], 0
    s_mov_b32 s48, 0x30000
    buffer_load_dwordx4 v[144:147], v2, s[8:11], s48 offen offset:0 nt
    s_waitcnt vmcnt(7)
    v_perm_b32 v40, v213, v209, s50
    v_perm_b32 v41, v221, v217, s50
    v_perm_b32 v42, v229, v225, s50
    v_perm_b32 v43, v237, v233, s50
    v_mfma_f32_16x16x32_bf16 v[52:55], v[16:19], v[36:39], 0
    buffer_load_dwordx4 v[148:151], v2, s[8:11], s48 offen offset:1024 nt
    s_waitcnt vmcnt(7)
    v_perm_b32 v44, v213, v209, s51
    v_perm_b32 v45, v221, v217, s51
    v_perm_b32 v46, v229, v225, s51
    v_perm_b32 v47, v237, v233, s51
    v_mfma_f32_16x16x32_bf16 v[56:59], v[16:19], v[40:43], 0
    buffer_load_dwordx4 v[152:155], v2, s[8:11], s48 offen offset:2048 nt
    s_waitcnt vmcnt(7)
    v_perm_b32 v32, v214, v210, s50
    v_perm_b32 v33, v222, v218, s50
    v_perm_b32 v34, v230, v226, s50
    v_perm_b32 v35, v238, v234, s50
    v_mfma_f32_16x16x32_bf16 v[60:63], v[16:19], v[44:47], 0
    buffer_load_dwordx4 v[156:159], v2, s[8:11], s48 offen offset:3072 nt
    s_waitcnt vmcnt(7)
    v_perm_b32 v36, v214, v210, s51
    v_perm_b32 v37, v222, v218, s51
    v_perm_b32 v38, v230, v226, s51
    v_perm_b32 v39, v238, v234, s51
    v_mfma_f32_16x16x32_bf16 v[64:67], v[16:19], v[32:35], 0
    s_mov_b32 s48, 0x31000
    buffer_load_dwordx4 v[160:163], v2, s[8:11], s48 offen offset:0 nt
    s_waitcnt vmcnt(7)
    v_perm_b32 v40, v215, v211, s50
    v_perm_b32 v41, v223, v219, s50
    v_perm_b32 v42, v231, v227, s50
    v_perm_b32 v43, v239, v235, s50
    v_mfma_f32_16x16x32_bf16 v[68:71], v[16:19], v[36:39], 0
    buffer_load_dwordx4 v[164:167], v2, s[8:11], s48 offen offset:1024 nt
    s_waitcnt vmcnt(5)
    v_perm_b32 v44, v215, v211, s51
    v_perm_b32 v45, v223, v219, s51
    v_perm_b32 v46, v231, v227, s51
    v_perm_b32 v47, v239, v235, s51
    v_mfma_f32_16x16x32_bf16 v[72:75], v[16:19], v[40:43], 0
    buffer_load_dwordx4 v[168:171], v2, s[8:11], s48 offen offset:2048 nt
    s_waitcnt vmcnt(5)
    v_mfma_f32_16x16x32_bf16 v[76:79], v[16:19], v[44:47], 0
    buffer_load_dwordx4 v[172:175], v2, s[8:11], s48 offen offset:3072 nt
    s_waitcnt vmcnt(5)
    v_bfe_u32 v12, v0, 3, 2
    v_lshlrev_b32 v12, 17, v12
    v_lshrrev_b32 v13, 5, v0
    v_lshl_add_u32 v12, v13, 10, v12
    v_and_b32 v13, 7, v0
    v_lshrrev_b32 v14, 4, v0
    v_lshlrev_b32 v14, 1, v14
    v_xor_b32 v13, v13, v14
    v_lshl_add_u32 v12, v13, 4, v12
    s_lshl_b32 s55, s44, 19
    s_lshr_b32 s56, s45, 3
    s_lshl_b32 s56, s56, 15
    s_add_u32 s55, s55, s56
    s_and_b32 s56, s45, 7
    s_lshl_b32 s56, s56, 7
    s_add_u32 s55, s55, s56
    s_lshl_b32 s56, s3, 12
    s_add_u32 s55, s55, s56
    s_lshl_b32 s63, s3, 11
    s_add_u32 m0, s63, 8448
    s_nop 0
    buffer_load_dwordx4 v12, s[36:39], s55 offen nt lds
    s_add_u32 s55, s55, 2048
    s_add_u32 m0, s63, 9472
    s_nop 0
    buffer_load_dwordx4 v12, s[36:39], s55 offen nt lds
    v_lshrrev_b32 v12, 4, v0
    s_lshl_b32 s55, s3, 5
    s_lshl_b32 s56, s44, 2
    s_add_u32 s55, s55, s56
    v_add_u32 v12, s55, v12
    v_lshlrev_b32 v13, 5, v12
    s_mov_b32 s58, 0x50000
    buffer_load_dwordx4 v[240:243], v13, s[12:15], s58 offen sc1
    buffer_load_dwordx4 v[244:247], v13, s[12:15], s58 offen offset:16 sc1
    s_waitcnt vmcnt(20)
    v_perm_b32 v32, v84, v80, s50
    v_perm_b32 v33, v92, v88, s50
    v_perm_b32 v34, v100, v96, s50
    v_perm_b32 v35, v108, v104, s50
    v_perm_b32 v36, v84, v80, s51
    v_perm_b32 v37, v92, v88, s51
    v_perm_b32 v38, v100, v96, s51
    v_perm_b32 v39, v108, v104, s51
    v_mfma_f32_16x16x32_bf16 v[48:51], v[20:23], v[32:35], v[48:51]
    v_perm_b32 v40, v85, v81, s50
    v_perm_b32 v41, v93, v89, s50
    v_perm_b32 v42, v101, v97, s50
    v_perm_b32 v43, v109, v105, s50
    v_mfma_f32_16x16x32_bf16 v[52:55], v[20:23], v[36:39], v[52:55]
    v_perm_b32 v44, v85, v81, s51
    v_perm_b32 v45, v93, v89, s51
    v_perm_b32 v46, v101, v97, s51
    v_perm_b32 v47, v109, v105, s51
    v_mfma_f32_16x16x32_bf16 v[56:59], v[20:23], v[40:43], v[56:59]
    v_perm_b32 v32, v86, v82, s50
    v_perm_b32 v33, v94, v90, s50
    v_perm_b32 v34, v102, v98, s50
    v_perm_b32 v35, v110, v106, s50
    v_mfma_f32_16x16x32_bf16 v[60:63], v[20:23], v[44:47], v[60:63]
    v_perm_b32 v36, v86, v82, s51
    v_perm_b32 v37, v94, v90, s51
    v_perm_b32 v38, v102, v98, s51
    v_perm_b32 v39, v110, v106, s51
    v_mfma_f32_16x16x32_bf16 v[64:67], v[20:23], v[32:35], v[64:67]
    v_perm_b32 v40, v87, v83, s50
    v_perm_b32 v41, v95, v91, s50
    v_perm_b32 v42, v103, v99, s50
    v_perm_b32 v43, v111, v107, s50
    v_mfma_f32_16x16x32_bf16 v[68:71], v[20:23], v[36:39], v[68:71]
    v_perm_b32 v44, v87, v83, s51
    v_perm_b32 v45, v95, v91, s51
    v_perm_b32 v46, v103, v99, s51
    v_perm_b32 v47, v111, v107, s51
    v_mfma_f32_16x16x32_bf16 v[72:75], v[20:23], v[40:43], v[72:75]
    s_nop 0
    v_mfma_f32_16x16x32_bf16 v[76:79], v[20:23], v[44:47], v[76:79]
    s_waitcnt vmcnt(12)
    v_perm_b32 v32, v116, v112, s50
    v_perm_b32 v33, v124, v120, s50
    v_perm_b32 v34, v132, v128, s50
    v_perm_b32 v35, v140, v136, s50
    v_perm_b32 v36, v116, v112, s51
    v_perm_b32 v37, v124, v120, s51
    v_perm_b32 v38, v132, v128, s51
    v_perm_b32 v39, v140, v136, s51
    v_mfma_f32_16x16x32_bf16 v[48:51], v[24:27], v[32:35], v[48:51]
    v_perm_b32 v40, v117, v113, s50
    v_perm_b32 v41, v125, v121, s50
    v_perm_b32 v42, v133, v129, s50
    v_perm_b32 v43, v141, v137, s50
    v_mfma_f32_16x16x32_bf16 v[52:55], v[24:27], v[36:39], v[52:55]
    v_perm_b32 v44, v117, v113, s51
    v_perm_b32 v45, v125, v121, s51
    v_perm_b32 v46, v133, v129, s51
    v_perm_b32 v47, v141, v137, s51
    v_mfma_f32_16x16x32_bf16 v[56:59], v[24:27], v[40:43], v[56:59]
    v_perm_b32 v32, v118, v114, s50
    v_perm_b32 v33, v126, v122, s50
    v_perm_b32 v34, v134, v130, s50
    v_perm_b32 v35, v142, v138, s50
    v_mfma_f32_16x16x32_bf16 v[60:63], v[24:27], v[44:47], v[60:63]
    v_perm_b32 v36, v118, v114, s51
    v_perm_b32 v37, v126, v122, s51
    v_perm_b32 v38, v134, v130, s51
    v_perm_b32 v39, v142, v138, s51
    v_mfma_f32_16x16x32_bf16 v[64:67], v[24:27], v[32:35], v[64:67]
    v_perm_b32 v40, v119, v115, s50
    v_perm_b32 v41, v127, v123, s50
    v_perm_b32 v42, v135, v131, s50
    v_perm_b32 v43, v143, v139, s50
    v_mfma_f32_16x16x32_bf16 v[68:71], v[24:27], v[36:39], v[68:71]
    v_perm_b32 v44, v119, v115, s51
    v_perm_b32 v45, v127, v123, s51
    v_perm_b32 v46, v135, v131, s51
    v_perm_b32 v47, v143, v139, s51
    v_mfma_f32_16x16x32_bf16 v[72:75], v[24:27], v[40:43], v[72:75]
    s_nop 0
    v_mfma_f32_16x16x32_bf16 v[76:79], v[24:27], v[44:47], v[76:79]
    s_mul_i32 s55, s3, 2176
    v_add_u32 v232, s55, v3
    v_lshrrev_b32 v12, 4, v0
    s_lshl_b32 s55, s3, 5
    s_lshl_b32 s56, s44, 2
    s_add_u32 s55, s55, s56
    v_add_u32 v12, s55, v12
    v_lshlrev_b32 v12, 11, v12
    v_and_b32 v13, 15, v0
    v_lshl_add_u32 v233, v13, 4, v12
    s_lshr_b32 s59, s45, 3
    s_lshl_b32 s59, s59, 9
    s_add_u32 s59, s59, 0x60000
    s_mul_i32 s55, s3, 272
    v_lshlrev_b32 v13, 3, v13
    v_lshrrev_b32 v12, 4, v0
    v_lshl_add_u32 v13, v12, 1, v13
    v_add_u32 v234, s55, v13
    v_lshrrev_b32 v12, 4, v0
    s_mul_i32 s55, s3, 272
    v_lshlrev_b32 v235, 4, v12
    v_add_u32 v235, s55, v235
    v_and_b32 v13, 15, v0
    v_lshlrev_b32 v236, 11, v13
    v_lshl_add_u32 v236, v12, 4, v236
    s_and_b32 s60, s45, 7
    s_lshl_b32 s60, s60, 2
    s_lshl_b32 s55, s3, 5
    s_add_u32 s60, s60, s55
    s_lshl_b32 s60, s60, 11
    s_lshl_b32 s55, s44, 2
    s_lshr_b32 s56, s45, 3
    s_add_u32 s55, s55, s56
    s_lshl_b32 s55, s55, 6
    s_add_u32 s60, s60, s55
    s_add_u32 s60, s60, 0x100000
    v_bfe_u32 v13, v0, 2, 2
    v_lshl_add_u32 v14, v12, 3, v13
    v_lshlrev_b32 v14, 7, v14
    v_and_b32 v15, 3, v0
    v_lshl_add_u32 v14, v15, 3, v14
    v_lshrrev_b32 v13, 1, v13
    v_lshl_add_u32 v224, v13, 5, v14
    v_add_u32 v13, 2, v13
    v_and_b32 v13, 3, v13
    v_lshl_add_u32 v228, v13, 5, v14
    v_add_u32 v228, 512, v228
    v_xor_b32 v225, 32, v224
    v_xor_b32 v229, 32, v228
    v_xor_b32 v226, 64, v224
    v_xor_b32 v230, 64, v228
    v_xor_b32 v227, 96, v224
    v_xor_b32 v231, 96, v228
    v_lshrrev_b32 v14, 3, v0
    s_lshl_b32 s55, s3, 3
    v_add_u32 v14, s55, v14
    v_and_b32 v13, 7, v0
    v_mul_u32_u24 v238, 272, v13
    v_lshl_add_u32 v238, v14, 4, v238
    s_lshl_b32 s55, s3, 10
    v_add_u32 v239, s55, v3
    s_lshl_b32 s61, s46, 11
    s_add_u32 s61, s61, 0x60000
    s_waitcnt vmcnt(4)
    v_perm_b32 v32, v148, v144, s50
    v_perm_b32 v33, v156, v152, s50
    v_perm_b32 v34, v164, v160, s50
    v_perm_b32 v35, v172, v168, s50
    v_perm_b32 v36, v148, v144, s51
    v_perm_b32 v37, v156, v152, s51
    v_perm_b32 v38, v164, v160, s51
    v_perm_b32 v39, v172, v168, s51
    v_mfma_f32_16x16x32_bf16 v[48:51], v[28:31], v[32:35], v[48:51]
    v_perm_b32 v40, v149, v145, s50
    v_perm_b32 v41, v157, v153, s50
    v_perm_b32 v42, v165, v161, s50
    v_perm_b32 v43, v173, v169, s50
    v_mfma_f32_16x16x32_bf16 v[52:55], v[28:31], v[36:39], v[52:55]
    v_perm_b32 v44, v149, v145, s51
    v_perm_b32 v45, v157, v153, s51
    v_perm_b32 v46, v165, v161, s51
    v_perm_b32 v47, v173, v169, s51
    v_mfma_f32_16x16x32_bf16 v[56:59], v[28:31], v[40:43], v[56:59]
    v_perm_b32 v32, v150, v146, s50
    v_perm_b32 v33, v158, v154, s50
    v_perm_b32 v34, v166, v162, s50
    v_perm_b32 v35, v174, v170, s50
    v_mfma_f32_16x16x32_bf16 v[60:63], v[28:31], v[44:47], v[60:63]
    v_perm_b32 v36, v150, v146, s51
    v_perm_b32 v37, v158, v154, s51
    v_perm_b32 v38, v166, v162, s51
    v_perm_b32 v39, v174, v170, s51
    v_mfma_f32_16x16x32_bf16 v[64:67], v[28:31], v[32:35], v[64:67]
    v_perm_b32 v40, v151, v147, s50
    v_perm_b32 v41, v159, v155, s50
    v_perm_b32 v42, v167, v163, s50
    v_perm_b32 v43, v175, v171, s50
    v_mfma_f32_16x16x32_bf16 v[68:71], v[28:31], v[36:39], v[68:71]
    v_perm_b32 v44, v151, v147, s51
    v_perm_b32 v45, v159, v155, s51
    v_perm_b32 v46, v167, v163, s51
    v_perm_b32 v47, v175, v171, s51
    v_mfma_f32_16x16x32_bf16 v[72:75], v[28:31], v[40:43], v[72:75]
    s_nop 0
    v_mfma_f32_16x16x32_bf16 v[76:79], v[28:31], v[44:47], v[76:79]
    s_mov_b32 exec_lo, 0xffff
    s_mov_b32 exec_hi, 0x0
    ds_write_b128 v232, v[48:51] offset:24832
    ds_write_b128 v232, v[52:55] offset:25104
    ds_write_b128 v232, v[56:59] offset:25376
    ds_write_b128 v232, v[60:63] offset:25648
    ds_write_b128 v232, v[64:67] offset:25920
    ds_write_b128 v232, v[68:71] offset:26192
    ds_write_b128 v232, v[72:75] offset:26464
    ds_write_b128 v232, v[76:79] offset:26736
    s_mov_b64 exec, -1
    s_waitcnt vmcnt(0) lgkmcnt(0)
    s_barrier
    s_cmp_gt_u32 s3, 1
    s_cbranch_scc1 L_no_opub
    ds_read_b128 v[48:51], v238 offset:24832
    ds_read_b128 v[52:55], v238 offset:27008
    ds_read_b128 v[56:59], v238 offset:29184
    ds_read_b128 v[60:63], v238 offset:31360
    ds_read_b128 v[64:67], v238 offset:33536
    ds_read_b128 v[68:71], v238 offset:35712
    ds_read_b128 v[72:75], v238 offset:37888
    ds_read_b128 v[76:79], v238 offset:40064
    s_waitcnt lgkmcnt(0)
    v_add_f32 v48, v48, v52
    v_add_f32 v56, v56, v60
    v_add_f32 v64, v64, v68
    v_add_f32 v72, v72, v76
    v_add_f32 v49, v49, v53
    v_add_f32 v57, v57, v61
    v_add_f32 v65, v65, v69
    v_add_f32 v73, v73, v77
    v_add_f32 v50, v50, v54
    v_add_f32 v58, v58, v62
    v_add_f32 v66, v66, v70
    v_add_f32 v74, v74, v78
    v_add_f32 v51, v51, v55
    v_add_f32 v59, v59, v63
    v_add_f32 v67, v67, v71
    v_add_f32 v75, v75, v79
    v_add_f32 v48, v48, v56
    v_add_f32 v64, v64, v72
    v_add_f32 v49, v49, v57
    v_add_f32 v65, v65, v73
    v_add_f32 v50, v50, v58
    v_add_f32 v66, v66, v74
    v_add_f32 v51, v51, v59
    v_add_f32 v67, v67, v75
    v_add_f32 v48, v48, v64
    v_add_f32 v49, v49, v65
    v_add_f32 v50, v50, v66
    v_add_f32 v51, v51, v67
    v_add_u32 v48, 0x80, v48
    v_add_u32 v49, 0x80, v49
    v_add_u32 v50, 0x80, v50
    v_add_u32 v51, 0x80, v51
    v_and_or_b32 v48, v48, s52, v5
    v_and_or_b32 v49, v49, s52, v5
    v_and_or_b32 v50, v50, s52, v5
    v_and_or_b32 v51, v51, s52, v5
    buffer_store_dwordx4 v[48:51], v239, s[12:15], s61 offen sc1
L_no_opub:
    buffer_load_dwordx4 v[24:27], v233, s[12:15], s59 offen sc1
    buffer_load_dwordx4 v[28:31], v233, s[12:15], s59 offen offset:256 sc1
    ds_read_b64_tr_b16 v[80:81], v224 offset:8448
    ds_read_b64_tr_b16 v[82:83], v228 offset:8448
    ds_read_b64_tr_b16 v[84:85], v224 offset:12544
    ds_read_b64_tr_b16 v[86:87], v228 offset:12544
    ds_read_b64_tr_b16 v[88:89], v224 offset:16640
    ds_read_b64_tr_b16 v[90:91], v228 offset:16640
    ds_read_b64_tr_b16 v[92:93], v224 offset:20736
    ds_read_b64_tr_b16 v[94:95], v228 offset:20736
    ds_read_b64_tr_b16 v[96:97], v225 offset:8448
    ds_read_b64_tr_b16 v[98:99], v229 offset:8448
    ds_read_b64_tr_b16 v[100:101], v225 offset:12544
    ds_read_b64_tr_b16 v[102:103], v229 offset:12544
    ds_read_b64_tr_b16 v[104:105], v225 offset:16640
    ds_read_b64_tr_b16 v[106:107], v229 offset:16640
    ds_read_b64_tr_b16 v[108:109], v225 offset:20736
    ds_read_b64_tr_b16 v[110:111], v229 offset:20736
    ds_read_b64_tr_b16 v[112:113], v226 offset:8448
    ds_read_b64_tr_b16 v[114:115], v230 offset:8448
    ds_read_b64_tr_b16 v[116:117], v226 offset:12544
    ds_read_b64_tr_b16 v[118:119], v230 offset:12544
    ds_read_b64_tr_b16 v[120:121], v226 offset:16640
    ds_read_b64_tr_b16 v[122:123], v230 offset:16640
    ds_read_b64_tr_b16 v[124:125], v226 offset:20736
    ds_read_b64_tr_b16 v[126:127], v230 offset:20736
    ds_read_b64_tr_b16 v[128:129], v227 offset:8448
    ds_read_b64_tr_b16 v[130:131], v231 offset:8448
    ds_read_b64_tr_b16 v[132:133], v227 offset:12544
    ds_read_b64_tr_b16 v[134:135], v231 offset:12544
    ds_read_b64_tr_b16 v[136:137], v227 offset:16640
    ds_read_b64_tr_b16 v[138:139], v231 offset:16640
    ds_read_b64_tr_b16 v[140:141], v227 offset:20736
    ds_read_b64_tr_b16 v[142:143], v231 offset:20736
    v_xor_b32 v240, v240, v5
    v_xor_b32 v241, v241, v5
    v_xor_b32 v242, v242, v5
    v_xor_b32 v243, v243, v5
    v_xor_b32 v244, v244, v5
    v_xor_b32 v245, v245, v5
    v_xor_b32 v246, v246, v5
    v_xor_b32 v247, v247, v5
    v_or3_b32 v32, v240, v242, v244
    v_or3_b32 v33, v241, v243, v245
    v_or_b32 v32, v32, v246
    v_or_b32 v33, v33, v247
    v_or_b32 v32, v32, v33
    v_and_b32 v32, 0xff, v32
    v_cmp_ne_u32 vcc, 0, v32
    s_cbranch_vccz L_ml_ok
    v_lshrrev_b32 v12, 4, v0
    s_lshl_b32 s55, s3, 5
    s_lshl_b32 s56, s44, 2
    s_add_u32 s55, s55, s56
    v_add_u32 v12, s55, v12
    v_lshlrev_b32 v13, 5, v12
    s_mov_b32 s58, 0x50000
    s_mov_b32 s54, 200000
    s_mov_b64 s[82:83], exec
L_ml_retry:
    s_mov_b64 exec, vcc
    buffer_load_dwordx4 v[240:243], v13, s[12:15], s58 offen sc1
    buffer_load_dwordx4 v[244:247], v13, s[12:15], s58 offen offset:16 sc1
    s_waitcnt vmcnt(0)
    v_xor_b32 v240, v240, v5
    v_xor_b32 v241, v241, v5
    v_xor_b32 v242, v242, v5
    v_xor_b32 v243, v243, v5
    v_xor_b32 v244, v244, v5
    v_xor_b32 v245, v245, v5
    v_xor_b32 v246, v246, v5
    v_xor_b32 v247, v247, v5
    v_or3_b32 v32, v240, v242, v244
    v_or3_b32 v33, v241, v243, v245
    v_or_b32 v32, v32, v246
    v_or_b32 v33, v33, v247
    v_or_b32 v32, v32, v33
    v_and_b32 v32, 0xff, v32
    v_cmp_ne_u32 vcc, 0, v32
    s_cbranch_vccz L_ml_rest
    s_sub_u32 s54, s54, 1
    s_cmp_lg_u32 s54, 0
    s_cbranch_scc1 L_ml_retry
L_ml_rest:
    s_mov_b64 exec, s[82:83]
L_ml_ok:
    v_mov_b32 v32, v240
    v_mov_b32 v33, v241
    v_mov_b32 v34, v242
    v_mov_b32 v35, v243
    v_mov_b32 v36, v32
    v_mov_b32 v37, v33
    v_mov_b32 v38, v34
    v_mov_b32 v39, v35
    v_permlane16_swap_b32 v32, v36
    v_permlane16_swap_b32 v33, v37
    v_permlane16_swap_b32 v34, v38
    v_permlane16_swap_b32 v35, v39
    v_max_f32 v32, v32, v36
    v_max_f32 v33, v33, v37
    v_max_f32 v34, v34, v38
    v_max_f32 v35, v35, v39
    v_mov_b32 v36, v32
    v_mov_b32 v37, v33
    v_mov_b32 v38, v34
    v_mov_b32 v39, v35
    v_permlane32_swap_b32 v32, v36
    v_permlane32_swap_b32 v33, v37
    v_permlane32_swap_b32 v34, v38
    v_permlane32_swap_b32 v35, v39
    v_max_f32 v32, v32, v36
    v_max_f32 v33, v33, v37
    v_max_f32 v34, v34, v38
    v_max_f32 v35, v35, v39
    v_sub_f32 v16, v240, v32
    v_sub_f32 v17, v241, v33
    v_sub_f32 v18, v242, v34
    v_sub_f32 v19, v243, v35
    v_exp_f32 v16, v16
    v_exp_f32 v17, v17
    v_exp_f32 v18, v18
    v_exp_f32 v19, v19
    v_mul_f32 v32, v16, v244
    v_mul_f32 v33, v17, v245
    v_mul_f32 v34, v18, v246
    v_mul_f32 v35, v19, v247
    v_mov_b32 v36, v32
    v_mov_b32 v37, v33
    v_mov_b32 v38, v34
    v_mov_b32 v39, v35
    v_permlane16_swap_b32 v32, v36
    v_permlane16_swap_b32 v33, v37
    v_permlane16_swap_b32 v34, v38
    v_permlane16_swap_b32 v35, v39
    v_add_f32 v32, v32, v36
    v_add_f32 v33, v33, v37
    v_add_f32 v34, v34, v38
    v_add_f32 v35, v35, v39
    v_mov_b32 v36, v32
    v_mov_b32 v37, v33
    v_mov_b32 v38, v34
    v_mov_b32 v39, v35
    v_permlane32_swap_b32 v32, v36
    v_permlane32_swap_b32 v33, v37
    v_permlane32_swap_b32 v34, v38
    v_permlane32_swap_b32 v35, v39
    v_add_f32 v32, v32, v36
    v_add_f32 v33, v33, v37
    v_add_f32 v34, v34, v38
    v_add_f32 v35, v35, v39
    v_rcp_f32 v36, v32
    v_rcp_f32 v37, v33
    v_rcp_f32 v38, v34
    v_rcp_f32 v39, v35
    v_fma_f32 v40, -v32, v36, 1.0
    v_fma_f32 v41, -v33, v37, 1.0
    v_fma_f32 v42, -v34, v38, 1.0
    v_fma_f32 v43, -v35, v39, 1.0
    v_fma_f32 v36, v40, v36, v36
    v_fma_f32 v37, v41, v37, v37
    v_fma_f32 v38, v42, v38, v38
    v_fma_f32 v39, v43, v39, v39
    v_mul_f32 v16, v16, v36
    v_mul_f32 v17, v17, v37
    v_mul_f32 v18, v18, v38
    v_mul_f32 v19, v19, v39
    s_waitcnt vmcnt(0)
    v_xor_b32 v24, v24, v5
    v_xor_b32 v25, v25, v5
    v_xor_b32 v26, v26, v5
    v_xor_b32 v27, v27, v5
    v_xor_b32 v28, v28, v5
    v_xor_b32 v29, v29, v5
    v_xor_b32 v30, v30, v5
    v_xor_b32 v31, v31, v5
    v_or3_b32 v32, v24, v26, v28
    v_or3_b32 v33, v25, v27, v29
    v_or_b32 v32, v32, v30
    v_or_b32 v33, v33, v31
    v_or_b32 v32, v32, v33
    v_and_b32 v32, 0xff, v32
    v_cmp_ne_u32 vcc, 0, v32
    s_cbranch_vccz L_o_ok
    s_mov_b32 s54, 200000
    s_mov_b64 s[82:83], exec
L_o_retry:
    s_mov_b64 exec, vcc
    buffer_load_dwordx4 v[24:27], v233, s[12:15], s59 offen sc1
    buffer_load_dwordx4 v[28:31], v233, s[12:15], s59 offen offset:256 sc1
    s_waitcnt vmcnt(0)
    v_xor_b32 v24, v24, v5
    v_xor_b32 v25, v25, v5
    v_xor_b32 v26, v26, v5
    v_xor_b32 v27, v27, v5
    v_xor_b32 v28, v28, v5
    v_xor_b32 v29, v29, v5
    v_xor_b32 v30, v30, v5
    v_xor_b32 v31, v31, v5
    v_or3_b32 v32, v24, v26, v28
    v_or3_b32 v33, v25, v27, v29
    v_or_b32 v32, v32, v30
    v_or_b32 v33, v33, v31
    v_or_b32 v32, v32, v33
    v_and_b32 v32, 0xff, v32
    v_cmp_ne_u32 vcc, 0, v32
    s_cbranch_vccz L_o_rest
    s_sub_u32 s54, s54, 1
    s_cmp_lg_u32 s54, 0
    s_cbranch_scc1 L_o_retry
L_o_rest:
    s_mov_b64 exec, s[82:83]
L_o_ok:
    v_mul_f32 v24, v24, v16
    v_mul_f32 v25, v25, v17
    v_mul_f32 v26, v26, v18
    v_mul_f32 v27, v27, v19
    v_mul_f32 v28, v28, v16
    v_mul_f32 v29, v29, v17
    v_mul_f32 v30, v30, v18
    v_mul_f32 v31, v31, v19
    v_permlane32_swap_b32 v24, v26
    v_permlane32_swap_b32 v25, v27
    v_permlane32_swap_b32 v28, v30
    v_permlane32_swap_b32 v29, v31
    v_add_f32 v24, v24, v26
    v_add_f32 v25, v25, v27
    v_add_f32 v28, v28, v30
    v_add_f32 v29, v29, v31
    v_permlane16_swap_b32 v24, v25
    s_nop 0
    v_permlane16_swap_b32 v28, v29
    v_add_f32 v24, v24, v25
    v_add_f32 v28, v28, v29
    v_cvt_pk_bf16_f32 v24, v24, v28
    ds_write_b16 v234, v24 offset:57856
    ds_write_b16_d16_hi v234, v24 offset:57984
    s_waitcnt lgkmcnt(0)
    ds_read_b128 v[144:147], v235 offset:57856
    ds_read_b128 v[148:151], v235 offset:57920
    ds_read_b128 v[152:155], v235 offset:57984
    ds_read_b128 v[156:159], v235 offset:58048
    s_waitcnt lgkmcnt(0)
    v_mfma_f32_16x16x32_bf16 v[160:163], v[80:83], v[144:147], 0
    v_mfma_f32_16x16x32_bf16 v[164:167], v[96:99], v[144:147], 0
    v_mfma_f32_16x16x32_bf16 v[168:171], v[112:115], v[144:147], 0
    v_mfma_f32_16x16x32_bf16 v[172:175], v[128:131], v[144:147], 0
    v_mfma_f32_16x16x32_bf16 v[160:163], v[84:87], v[148:151], v[160:163]
    v_mfma_f32_16x16x32_bf16 v[164:167], v[100:103], v[148:151], v[164:167]
    v_mfma_f32_16x16x32_bf16 v[168:171], v[116:119], v[148:151], v[168:171]
    v_mfma_f32_16x16x32_bf16 v[172:175], v[132:135], v[148:151], v[172:175]
    v_mfma_f32_16x16x32_bf16 v[160:163], v[88:91], v[152:155], v[160:163]
    v_mfma_f32_16x16x32_bf16 v[164:167], v[104:107], v[152:155], v[164:167]
    v_mfma_f32_16x16x32_bf16 v[168:171], v[120:123], v[152:155], v[168:171]
    v_mfma_f32_16x16x32_bf16 v[172:175], v[136:139], v[152:155], v[172:175]
    v_mfma_f32_16x16x32_bf16 v[160:163], v[92:95], v[156:159], v[160:163]
    v_mfma_f32_16x16x32_bf16 v[164:167], v[108:111], v[156:159], v[164:167]
    v_mfma_f32_16x16x32_bf16 v[168:171], v[124:127], v[156:159], v[168:171]
    v_mfma_f32_16x16x32_bf16 v[172:175], v[140:143], v[156:159], v[172:175]
    v_and_b32 v13, 15, v0
    v_cmp_eq_u32 vcc, 1, v13
    s_nop 3
    v_cndmask_b32 v160, v160, v164, vcc
    v_cndmask_b32 v161, v161, v165, vcc
    v_cndmask_b32 v162, v162, v166, vcc
    v_cndmask_b32 v163, v163, v167, vcc
    v_cmp_eq_u32 vcc, 2, v13
    s_nop 1
    v_cndmask_b32 v160, v160, v168, vcc
    v_cndmask_b32 v161, v161, v169, vcc
    v_cndmask_b32 v162, v162, v170, vcc
    v_cndmask_b32 v163, v163, v171, vcc
    v_cmp_eq_u32 vcc, 3, v13
    s_nop 1
    v_cndmask_b32 v160, v160, v172, vcc
    v_cndmask_b32 v161, v161, v173, vcc
    v_cndmask_b32 v162, v162, v174, vcc
    v_cndmask_b32 v163, v163, v175, vcc
    s_mov_b32 exec_lo, 0xf000f
    s_mov_b32 exec_hi, 0xf000f
    v_add_u32 v160, 0x80, v160
    v_add_u32 v161, 0x80, v161
    v_add_u32 v162, 0x80, v162
    v_add_u32 v163, 0x80, v163
    v_and_or_b32 v160, v160, s52, v5
    v_and_or_b32 v161, v161, s52, v5
    v_and_or_b32 v162, v162, s52, v5
    v_and_or_b32 v163, v163, s52, v5
    buffer_store_dwordx4 v[160:163], v236, s[12:15], s60 offen sc1
    s_mov_b64 exec, -1
    s_barrier
    s_cmp_lg_u32 s3, 7
    s_cbranch_scc1 L_end
    s_lshl_b32 s55, s46, 11
    s_add_u32 s55, s55, 0x100000
    s_lshl_b32 s56, s46, 10
    s_add_u32 s56, s56, 0x200000
    v_and_b32 v13, 3, v0
    v_bfe_u32 v14, v0, 4, 1
    v_lshl_add_u32 v14, v13, 2, v14
    v_lshlrev_b32 v14, 1, v14
    s_lshl_b32 s57, s46, 5
    buffer_load_ushort v40, v14, s[16:19], s57 offen
    buffer_load_ushort v41, v14, s[16:19], s57 offen offset:4
    v_mov_b32 v24, v5
    v_mov_b32 v25, v5
    v_mov_b32 v26, v5
    v_mov_b32 v27, v5
    buffer_load_dwordx4 v[16:19], v3, s[12:15], s55 offen offset:0 sc1
    buffer_load_dwordx4 v[20:23], v3, s[12:15], s55 offen offset:1024 sc1
    s_mov_b64 s[84:85], exec
    s_and_b32 exec_hi, exec_hi, 0xffffff
    s_cbranch_execz L_fin_nod0
    buffer_load_dwordx4 v[24:27], v3, s[12:15], s56 offen sc1
L_fin_nod0:
    s_mov_b64 exec, s[84:85]
    s_waitcnt vmcnt(0)
    v_xor_b32 v16, v16, v5
    v_xor_b32 v17, v17, v5
    v_xor_b32 v18, v18, v5
    v_xor_b32 v19, v19, v5
    v_xor_b32 v20, v20, v5
    v_xor_b32 v21, v21, v5
    v_xor_b32 v22, v22, v5
    v_xor_b32 v23, v23, v5
    v_xor_b32 v24, v24, v5
    v_xor_b32 v25, v25, v5
    v_xor_b32 v26, v26, v5
    v_xor_b32 v27, v27, v5
    v_or3_b32 v44, v16, v18, v20
    v_or3_b32 v45, v17, v19, v21
    v_or3_b32 v44, v44, v22, v24
    v_or3_b32 v45, v45, v23, v25
    v_or_b32 v44, v44, v26
    v_or_b32 v45, v45, v27
    v_or_b32 v44, v44, v45
    v_and_b32 v44, 0xff, v44
    v_cmp_ne_u32 vcc, 0, v44
    s_cbranch_vccz L_fin_ok
    s_mov_b32 s54, 200000
    s_mov_b64 s[82:83], exec
L_fin_retry:
    s_mov_b64 exec, vcc
    v_mov_b32 v24, v5
    v_mov_b32 v25, v5
    v_mov_b32 v26, v5
    v_mov_b32 v27, v5
    buffer_load_dwordx4 v[16:19], v3, s[12:15], s55 offen offset:0 sc1
    buffer_load_dwordx4 v[20:23], v3, s[12:15], s55 offen offset:1024 sc1
    s_mov_b64 s[84:85], exec
    s_and_b32 exec_hi, exec_hi, 0xffffff
    s_cbranch_execz L_fin_nod1
    buffer_load_dwordx4 v[24:27], v3, s[12:15], s56 offen sc1
L_fin_nod1:
    s_mov_b64 exec, s[84:85]
    s_waitcnt vmcnt(0)
    v_xor_b32 v16, v16, v5
    v_xor_b32 v17, v17, v5
    v_xor_b32 v18, v18, v5
    v_xor_b32 v19, v19, v5
    v_xor_b32 v20, v20, v5
    v_xor_b32 v21, v21, v5
    v_xor_b32 v22, v22, v5
    v_xor_b32 v23, v23, v5
    v_xor_b32 v24, v24, v5
    v_xor_b32 v25, v25, v5
    v_xor_b32 v26, v26, v5
    v_xor_b32 v27, v27, v5
    v_or3_b32 v44, v16, v18, v20
    v_or3_b32 v45, v17, v19, v21
    v_or3_b32 v44, v44, v22, v24
    v_or3_b32 v45, v45, v23, v25
    v_or_b32 v44, v44, v26
    v_or_b32 v45, v45, v27
    v_or_b32 v44, v44, v45
    v_and_b32 v44, 0xff, v44
    v_cmp_ne_u32 vcc, 0, v44
    s_cbranch_vccz L_fin_rest
    s_sub_u32 s54, s54, 1
    s_cmp_lg_u32 s54, 0
    s_cbranch_scc1 L_fin_retry
L_fin_rest:
    s_mov_b64 exec, s[82:83]
L_fin_ok:
    v_add_f32 v16, v16, v20
    v_add_f32 v17, v17, v21
    v_add_f32 v18, v18, v22
    v_add_f32 v19, v19, v23
    v_permlane32_swap_b32 v16, v24
    v_permlane32_swap_b32 v17, v25
    v_permlane32_swap_b32 v18, v26
    v_permlane32_swap_b32 v19, v27
    v_add_f32 v16, v16, v24
    v_add_f32 v17, v17, v25
    v_add_f32 v18, v18, v26
    v_add_f32 v19, v19, v27
    v_permlane16_swap_b32 v16, v17
    s_nop 0
    v_permlane16_swap_b32 v18, v19
    v_add_f32 v16, v16, v17
    v_add_f32 v18, v18, v19
    s_nop 0
    v_add_f32_dpp v16, v16, v16 row_ror:4 row_mask:0xf bank_mask:0xf
    v_add_f32_dpp v18, v18, v18 row_ror:4 row_mask:0xf bank_mask:0xf
    s_nop 0
    v_add_f32_dpp v16, v16, v16 row_ror:8 row_mask:0xf bank_mask:0xf
    v_add_f32_dpp v18, v18, v18 row_ror:8 row_mask:0xf bank_mask:0xf
    v_mov_b32 v24, v16
    v_mov_b32 v25, v18
    s_nop 0
    v_permlane32_swap_b32 v16, v24
    v_permlane32_swap_b32 v18, v25
    v_cvt_pk_bf16_f32 v44, v16, v18
    v_cvt_pk_bf16_f32 v45, v24, v25
    v_lshlrev_b32 v46, 16, v45
    v_and_b32 v47, s53, v45
    v_mul_f32 v48, 0xbfb8aa3b, v46
    v_mul_f32 v49, 0xbfb8aa3b, v47
    v_exp_f32 v48, v48
    v_exp_f32 v49, v49
    v_add_f32 v48, 1.0, v48
    v_add_f32 v49, 1.0, v49
    v_rcp_f32 v48, v48
    v_rcp_f32 v49, v49
    v_lshlrev_b32 v50, 16, v44
    v_and_b32 v51, s53, v44
    v_mul_f32 v48, v46, v48
    v_mul_f32 v49, v47, v49
    v_cvt_pk_bf16_f32 v48, v48, v49
    v_lshlrev_b32 v46, 16, v48
    v_and_b32 v47, s53, v48
    v_mul_f32 v46, v50, v46
    v_mul_f32 v47, v51, v47
    v_cvt_pk_bf16_f32 v48, v46, v47
    v_lshlrev_b32 v46, 16, v48
    v_and_b32 v47, s53, v48
    v_lshlrev_b32 v40, 16, v40
    v_lshlrev_b32 v41, 16, v41
    v_add_f32 v46, v46, v40
    v_add_f32 v47, v47, v41
    v_cvt_pk_bf16_f32 v48, v46, v47
    s_mov_b32 exec_lo, 0xf000f
    s_mov_b32 exec_hi, 0x0
    buffer_store_short v48, v14, s[40:43], s57 offen
    buffer_store_short_d16_hi v48, v14, s[40:43], s57 offen offset:4
    s_cmp_lg_u32 s2, 0
    s_cbranch_scc1 L_no_epoch
    s_mov_b32 exec_lo, 0x1
    s_mov_b32 exec_hi, 0x0
    v_mov_b32 v50, s47
    v_mov_b32 v51, 0
    buffer_store_dword v50, v51, s[12:15], 0 offen offset:0
L_no_epoch:
    s_mov_b64 exec, -1
L_end:
    s_endpgm
.section .rodata,"a"
.p2align 6
.amdhsa_kernel recurrent_scan__gqa_block_cached__glu_gated_glu__decode_kernel
  .amdhsa_next_free_vgpr 248
  .amdhsa_next_free_sgpr 102
  .amdhsa_accum_offset 248
  .amdhsa_group_segment_fixed_size 0
  .amdhsa_kernarg_size 96
  .amdhsa_user_sgpr_count 2
  .amdhsa_user_sgpr_kernarg_segment_ptr 1
  .amdhsa_system_sgpr_workgroup_id_x 1
  .amdhsa_float_denorm_mode_32 3
.end_amdhsa_kernel
```
